```python
import torch

def _softmax(x, axis=-1):
    return torch.softmax(x, dim=axis)
def _gelu(x):
    return torch.nn.functional.gelu(x, approximate="tanh")
def _silu(x):
    return torch.nn.functional.silu(x)
def _sigmoid(x):
    return torch.sigmoid(x)
def _layernorm(x, axis=-1, eps=1e-5):
    m = x.mean(dim=axis, keepdim=True)
    v = x.var(dim=axis, keepdim=True, unbiased=False)
    return (x - m) / torch.sqrt(v + eps)
def _scatter_add(tgt, idx, src, axis=0):
    return tgt.clone().index_add_(axis, idx, src)
def _segment_sum(src, seg, n):
    out = torch.zeros((n,) + src.shape[1:], dtype=src.dtype)
    return out.index_add_(0, seg, src)
def _pad(x, pw):
    flat = tuple(v for pair in reversed(pw) for v in pair)
    return torch.nn.functional.pad(x, flat)

kernel_name = 'interleave_layers__sliding_block_cached__sliding_block_cached__decode'

def setup_inputs():

    _w = (lambda a: (lambda t: t.to(torch.bfloat16) if t.is_floating_point() else t)(torch.as_tensor(a)))
    def _A_setup():
        B, Sq, D = 2, 1, 576
        Hq, Hkv, Sk, Dh = 32, 16, 4096, 128
        assert Hq % Hkv == 0, (Hq, Hkv)
        return {
            "x": _w((lambda *s: torch.randn(*s, dtype=torch.bfloat16) * 0.05)(B, Sq, D)),
            "k_cache": _w((lambda *s: torch.randn(*s, dtype=torch.bfloat16) * 0.8)(B, Hkv, Sk, Dh)),
            "v_cache": _w((lambda *s: torch.randn(*s, dtype=torch.bfloat16) * 1.6)(B, Hkv, Sk, Dh)),
            "wq": _w((lambda *s: torch.randn(*s, dtype=torch.bfloat16) * 0.8)(D, Hq * Dh) * (D ** -0.5)),
            "wo": _w((lambda *s: torch.randn(*s, dtype=torch.bfloat16) * 1.6)(Hq * Dh, D) * ((Hq * Dh) ** -0.5)),
        }
    _A_in = _A_setup()

    def _B_setup():
        B, Sq, D = 2, 1, 576
        Hq, Hkv, Sk, Dh = 32, 16, 4096, 128
        assert Hq % Hkv == 0, (Hq, Hkv)
        return {
            "x": _w((lambda *s: torch.randn(*s, dtype=torch.bfloat16) * 0.05)(B, Sq, D)),
            "k_cache": _w((lambda *s: torch.randn(*s, dtype=torch.bfloat16) * 3.2)(B, Hkv, Sk, Dh)),
            "v_cache": _w((lambda *s: torch.randn(*s, dtype=torch.bfloat16) * 0.4)(B, Hkv, Sk, Dh)),
            "wq": _w((lambda *s: torch.randn(*s, dtype=torch.bfloat16) * 3.2)(D, Hq * Dh) * (D ** -0.5)),
            "wo": _w((lambda *s: torch.randn(*s, dtype=torch.bfloat16) * 0.4)(Hq * Dh, D) * ((Hq * Dh) ** -0.5)),
        }
    _B_in = _B_setup()

    return {
        "A_x": _A_in["x"],
        "A_k_cache": _A_in["k_cache"],
        "A_v_cache": _A_in["v_cache"],
        "A_wq": _A_in["wq"],
        "A_wo": _A_in["wo"],
        "B_x": _B_in["x"],
        "B_k_cache": _B_in["k_cache"],
        "B_v_cache": _B_in["v_cache"],
        "B_wq": _B_in["wq"],
        "B_wo": _B_in["wo"],
    }

def reference(A_x, A_k_cache, A_v_cache, A_wq, A_wo, B_x, B_k_cache, B_v_cache, B_wq, B_wo):
    def _A_ref(x, k_cache, v_cache, wq, wo):
        B, Sq, D = x.shape
        Hq, Dh = 32, 128
        Hkv, Sk = k_cache.shape[1], k_cache.shape[2]
        W = min(4096, max(256, Sk // 4))
        rep = Hq // Hkv
        q = (lambda x, *d: x.permute(*d))((x @ wq).reshape(B, Sq, Hq, Dh), 0, 2, 1, 3)
        k = (lambda x, n, axis: torch.repeat_interleave(x, n, dim=axis))(k_cache[:, :, Sk - W:, :], rep, axis=1)
        v = (lambda x, n, axis: torch.repeat_interleave(x, n, dim=axis))(v_cache[:, :, Sk - W:, :], rep, axis=1)
        scores = torch.einsum("bhqd,bhkd->bhqk", q, k) * (Dh ** -0.5)
        p = _softmax(scores, axis=-1)
        o = torch.einsum("bhqk,bhkd->bhqd", p, v)
        return (lambda x, *d: x.permute(*d))(o, 0, 2, 1, 3).reshape(B, Sq, Hq * Dh) @ wo

    def _B_ref(x, k_cache, v_cache, wq, wo):
        B, Sq, D = x.shape
        Hq, Dh = 32, 128
        Hkv, Sk = k_cache.shape[1], k_cache.shape[2]
        W = min(4096, max(256, Sk // 4))
        rep = Hq // Hkv
        q = (lambda x, *d: x.permute(*d))((x @ wq).reshape(B, Sq, Hq, Dh), 0, 2, 1, 3)
        k = (lambda x, n, axis: torch.repeat_interleave(x, n, dim=axis))(k_cache[:, :, Sk - W:, :], rep, axis=1)
        v = (lambda x, n, axis: torch.repeat_interleave(x, n, dim=axis))(v_cache[:, :, Sk - W:, :], rep, axis=1)
        scores = torch.einsum("bhqd,bhkd->bhqk", q, k) * (Dh ** -0.5)
        p = _softmax(scores, axis=-1)
        o = torch.einsum("bhqk,bhkd->bhqd", p, v)
        return (lambda x, *d: x.permute(*d))(o, 0, 2, 1, 3).reshape(B, Sq, Hq * Dh) @ wo

    x = A_x
    x = x + _A_ref(_layernorm(x, axis=-1), A_k_cache, A_v_cache, A_wq, A_wo)
    x = x + _B_ref(_layernorm(x, axis=-1), B_k_cache, B_v_cache, B_wq, B_wo)
    x = x + _A_ref(_layernorm(x, axis=-1), A_k_cache, A_v_cache, A_wq, A_wo)
    x = x + _B_ref(_layernorm(x, axis=-1), B_k_cache, B_v_cache, B_wq, B_wo)
    return x
```

```asm
; @launch grid=(256,1,1) block=(512,1,1) lds=133120
.amdgcn_target "amdgcn-amd-amdhsa--gfx950"
.text
.globl interleave_layers__sliding_block_cached__sliding_block_cached__decode_kernel
.p2align 8
.type interleave_layers__sliding_block_cached__sliding_block_cached__decode_kernel,@function
interleave_layers__sliding_block_cached__sliding_block_cached__decode_kernel:
    s_lshr_b32 s33, s2, 3
    s_cmp_ge_u32 s33, 32
    s_cbranch_scc1 L_end
    s_load_dwordx2 s[20:21], s[0:1], 96
    s_load_dwordx8 s[40:47], s[0:1], 64
    s_load_dwordx16 s[48:63], s[0:1], 0
    v_mov_b64 v[32:33], 0
    v_mov_b64 v[64:65], 0
    v_mov_b64 v[112:113], 0
    v_lshrrev_b32 v2, 6, v0
    s_and_b32 s32, s2, 7
    v_readfirstlane_b32 s3, v2
    s_cmp_lt_u32 s33, 16
    s_cbranch_scc0 L_ftk
    s_and_b32 s98, s2, 0xe4
    s_cmp_eq_u32 s98, 64
    s_cbranch_scc0 L_role
    s_lshl2_add_u32 s98, s33, s32
    s_addk_i32 s98, 88
    s_lshl_b32 s99, s98, 13
    v_lshl_add_u32 v5, v0, 4, s99
    v_mov_b64 v[6:7], -1
    v_mov_b64 v[8:9], -1
    v_lshl_add_u32 v10, v0, 6, s98
    s_cmp_eq_u32 s3, 0
    s_waitcnt lgkmcnt(0)
    global_store_dwordx4 v5, v[6:9], s[20:21] sc1
    s_waitcnt vmcnt(0)
    s_barrier
    s_cbranch_scc0 L_role
    s_mov_b64 exec, 15
    global_store_byte v10, v6, s[46:47] offset:-120 sc1
    s_mov_b64 exec, -1
L_role:
    s_cmp_lt_u32 s3, 4
    s_cbranch_scc1 L_q
    s_branch L_o
L_ftk:
    s_lshr_b32 s97, s3, 1
    s_cmp_lt_u32 s3, 4
    s_cbranch_scc1 L_kv
    s_mul_i32 s98, s33, 0x108
    s_and_b32 s98, s98, 0x440
    s_lshl1_add_u32 s97, s97, s97
    s_add_u32 s98, s98, s97
    s_and_b32 s99, s33, 3
    s_add_u32 s98, s98, s99
    s_lshl_b32 s99, s32, 7
    s_add_u32 s98, s98, s99
    s_addk_i32 s98, 40
    s_lshl_b32 s98, s98, 7
    v_add_lshl_u32 v5, s98, v0, 7
    s_waitcnt lgkmcnt(0)
    global_load_dword v244, v5, s[50:51]
L_kv:
    v_and_b32 v1, 63, v0
    v_and_b32 v3, 15, v1
    v_lshrrev_b32 v4, 4, v1
    s_mov_b32 s22, 268435456
    s_mov_b32 s23, 0x20000
    s_mov_b32 s26, 256
    s_mov_b32 s27, 0x20000
    s_mov_b32 s7, 0x20000
    s_mov_b32 s11, 0x20000
    s_mov_b32 s37, 131072
    s_lshl_b32 s35, s32, 16
    s_mov_b32 s34, 0
    s_mov_b32 s36, 0
    s_mov_b32 s6, 33554432
    s_mov_b32 s10, 33554432
    s_bfe_u32 s12, s33, 0x10003
    s_bfe_u32 s13, s33, 0x10002
    s_and_b32 s14, s33, 3
    s_and_b32 s18, s3, 3
    s_lshl_b32 s96, s32, 1
    s_add_u32 s96, s96, s12
    s_lshl_b32 s96, s96, 20
    s_lshl_b32 s97, s13, 24
    s_add_u32 s96, s96, s97
    s_and_b32 s97, s14, 1
    s_lshl_b32 s97, s97, 14
    s_add_u32 s96, s96, s97
    s_lshr_b32 s97, s14, 1
    s_lshl_b32 s97, s97, 15
    s_add_u32 s96, s96, s97
    s_and_b32 s97, s18, 1
    s_lshl_b32 s97, s97, 12
    s_add_u32 s96, s96, s97
    s_lshr_b32 s97, s18, 1
    s_lshl_b32 s97, s97, 13
    s_add_u32 s96, s96, s97
    s_add_u32 s15, s96, 786432
    s_lshl_b32 s16, s3, 14
    s_cmp_lt_u32 s3, 4
    s_cselect_b32 s96, 3, 2
    v_and_b32 v5, s96, v4
    v_xor_b32 v5, v5, v3
    v_lshlrev_b32 v5, 4, v5
    v_lshl_add_u32 v8, v4, 8, v5
    v_xor_b32 v9, 64, v8
    v_xor_b32 v10, 128, v8
    v_xor_b32 v11, 192, v8
    s_waitcnt lgkmcnt(0)
    s_cselect_b64 s[4:5], s[50:51], s[52:53]
    s_cselect_b64 s[8:9], s[60:61], s[62:63]
    s_mov_b64 s[24:25], s[46:47]
    s_cbranch_scc0 L_v
    s_mov_b32 s30, 2304
    s_mov_b32 s31, 0x20000
    s_mov_b64 s[28:29], s[48:49]
    s_mul_i32 s97, s13, 1152
    v_lshlrev_b32 v5, 4, v1
    v_lshlrev_b32 v6, 2, v1
    v_mov_b32 v44, 0
    buffer_load_dwordx4 v[40:43], v5, s[28:31], s97 offen
    s_mov_b32 exec_hi, 0
    buffer_load_dword v44, v6, s[28:31], s97 offen offset:1024
    s_mov_b32 exec_hi, -1
    s_add_u32 m0, s16, 0
    s_add_u32 s96, s15, 0
    buffer_load_dwordx4 v8, s[4:7], s96 offen offset:0 nt lds
    buffer_load_dwordx4 v9, s[4:7], s96 offen offset:1024 nt lds
    buffer_load_dwordx4 v10, s[4:7], s96 offen offset:2048 nt lds
    buffer_load_dwordx4 v11, s[4:7], s96 offen offset:3072 nt lds
    s_add_u32 m0, s16, 4096
    s_add_u32 s96, s15, 65536
    buffer_load_dwordx4 v8, s[4:7], s96 offen offset:0 nt lds
    buffer_load_dwordx4 v9, s[4:7], s96 offen offset:1024 nt lds
    buffer_load_dwordx4 v10, s[4:7], s96 offen offset:2048 nt lds
    buffer_load_dwordx4 v11, s[4:7], s96 offen offset:3072 nt lds
    s_add_u32 m0, s16, 8192
    s_add_u32 s96, s15, 131072
    buffer_load_dwordx4 v8, s[4:7], s96 offen offset:0 nt lds
    buffer_load_dwordx4 v9, s[4:7], s96 offen offset:1024 nt lds
    buffer_load_dwordx4 v10, s[4:7], s96 offen offset:2048 nt lds
    buffer_load_dwordx4 v11, s[4:7], s96 offen offset:3072 nt lds
    s_add_u32 m0, s16, 12288
    s_add_u32 s96, s15, 196608
    buffer_load_dwordx4 v8, s[4:7], s96 offen offset:0 nt lds
    buffer_load_dwordx4 v9, s[4:7], s96 offen offset:1024 nt lds
    buffer_load_dwordx4 v10, s[4:7], s96 offen offset:2048 nt lds
    buffer_load_dwordx4 v11, s[4:7], s96 offen offset:3072 nt lds
    s_barrier
    v_xor_b32 v5, v4, v3
    v_lshlrev_b32 v5, 4, v5
    v_lshl_add_u32 v5, v3, 8, v5
    v_add_u32 v12, s16, v5
    v_xor_b32 v13, 64, v12
    v_xor_b32 v14, 128, v12
    v_xor_b32 v15, 192, v12
    s_lshl_b32 s96, s12, 11
    s_lshl_b32 s97, s13, 10
    s_add_u32 s96, s96, s97
    v_lshlrev_b32 v16, 4, v1
    v_add_u32 v16, s96, v16
    s_lshl_b32 s96, s12, 5
    s_lshl_b32 s97, s13, 4
    s_add_u32 s96, s96, s97
    s_add_u32 s96, s96, 14848
    v_mov_b32 v17, s96
    v_and_b32 v5, 2, v4
    v_lshrrev_b32 v6, 3, v3
    v_add_u32 v5, v5, v6
    v_lshlrev_b32 v5, 8, v5
    v_and_b32 v6, 1, v4
    v_lshl_add_u32 v5, v6, 6, v5
    v_and_b32 v7, 7, v3
    v_lshl_add_u32 v5, v7, 2, v5
    s_and_b32 s96, s3, 2
    s_lshl1_add_u32 s96, s96, s3
    s_and_b32 s96, s96, 5
    s_lshl_b32 s96, s96, 5
    s_add_u32 s96, s96, 131072
    v_add_u32 v18, s96, v5
    s_lshl_b32 s96, s3, 2
    s_add_u32 s96, s96, 132096
    v_add_u32 v5, s96, v1
    v_lshlrev_b32 v7, 2, v1
    v_add_u32 v7, 132160, v7
    v_and_b32 v19, 47, v1
    v_cmp_eq_u32 vcc, 0, v19
    s_nop 1
    v_cndmask_b32 v19, v7, v5, vcc
    s_lshl_b32 s96, s12, 9
    s_lshl_b32 s97, s13, 7
    s_add_u32 s96, s96, s97
    s_lshl_b32 s97, s14, 5
    s_add_u32 s96, s96, s97
    s_lshl_b32 s97, s3, 3
    s_add_u32 s96, s96, s97
    s_add_u32 s96, s96, 15360
    v_lshlrev_b32 v20, 8, v6
    v_add_u32 v20, s96, v20
    v_and_b32 v5, 1, v1
    v_mul_u32_u24 v21, 0xaaaa, v5
    v_add_u32 v21, 0x4444, v21
    v_lshlrev_b32 v22, 4, v6
    v_add_u32 v22, 132096, v22
    v_mov_b64 v[50:51], 0
    s_waitcnt vmcnt(16)
    v_dot2c_f32_bf16 v50, 0x3f803f80, v40
    v_dot2c_f32_bf16 v51, v40, v40
    v_dot2c_f32_bf16 v50, 0x3f803f80, v41
    v_dot2c_f32_bf16 v51, v41, v41
    v_dot2c_f32_bf16 v50, 0x3f803f80, v42
    v_dot2c_f32_bf16 v51, v42, v42
    v_dot2c_f32_bf16 v50, 0x3f803f80, v43
    v_dot2c_f32_bf16 v51, v43, v43
    v_dot2c_f32_bf16 v50, 0x3f803f80, v44
    v_dot2c_f32_bf16 v51, v44, v44
    s_nop 2
    v_permlane32_swap_b32 v50, v51
    v_add_f32 v52, v50, v51
    v_add_f32 v50, v50, v51
    s_nop 1
    v_permlane16_swap_b32 v50, v52
    v_add_f32 v50, v50, v52
    s_nop 1
    v_add_f32_dpp v50, v50, v50 quad_perm:[1,0,3,2] row_mask:0xf bank_mask:0xf
    s_nop 1
    v_add_f32_dpp v50, v50, v50 quad_perm:[2,3,0,1] row_mask:0xf bank_mask:0xf
    s_nop 1
    v_add_f32_dpp v50, v50, v50 row_ror:4 row_mask:0xf bank_mask:0xf
    s_nop 1
    v_add_f32_dpp v50, v50, v50 row_ror:8 row_mask:0xf bank_mask:0xf
    s_nop 0
    v_readlane_b32 s96, v50, 0
    v_readlane_b32 s97, v50, 32
    v_mov_b64 v[194:195], 0
    v_mov_b32 v192, s96
    v_mov_b32 v193, s97
    s_load_dwordx4 s[44:47], s[24:25], 128
    s_waitcnt lgkmcnt(0)
    s_and_b64 s[44:45], s[44:45], s[46:47]
    s_and_b32 s44, s44, s45
    s_cmp_eq_u32 s44, -1
    s_cbranch_scc1 L_flagd_1
    s_sleep 8
    s_load_dwordx4 s[44:47], s[24:25], 192
    s_waitcnt lgkmcnt(0)
    s_and_b64 s[44:45], s[44:45], s[46:47]
    s_and_b32 s44, s44, s45
    s_cmp_eq_u32 s44, -1
    s_cbranch_scc1 L_flagd_1
    s_sleep 8
L_poll_2:
    buffer_load_ubyte v58, v3, s[24:27], 0 offen offset:128 sc1
    s_sub_u32 s37, s37, 1
    s_cmp_lt_i32 s37, 0
    s_cbranch_scc1 L_pdone_3
    s_sleep 8
    s_waitcnt vmcnt(0)
    v_cmp_eq_u32 vcc, 0, v58
    s_cbranch_vccnz L_poll_2
L_pdone_3:
L_flagd_1:
    s_mov_b32 s40, 0x3c5f102d
    s_mov_b32 s41, 0x3ddaa8d5
    s_mov_b32 s42, 0x3a21369a
    v_lshlrev_b32 v56, 2, v3
    v_mov_b64 v[32:33], 0
    v_mov_b64 v[34:35], 0
    v_mov_b64 v[36:37], 0
    v_mov_b64 v[38:39], 0
    v_mov_b64 v[40:41], 0
    v_mov_b64 v[42:43], 0
    v_mov_b64 v[44:45], 0
    v_mov_b64 v[46:47], 0
    s_waitcnt vmcnt(0)
    s_cmp_eq_u32 s3, 0
    s_cbranch_scc0 L_skip_4
    s_getreg_b32 s96, hwreg(HW_REG_XCC_ID, 0, 4)
    s_lshr_b32 s97, s33, 4
    s_lshl_b32 s97, s97, 10
    s_and_b32 s98, s33, 15
    s_lshl_b32 s98, s98, 2
    s_add_u32 s97, s97, s98
    s_lshl_b32 s98, s32, 7
    s_add_u32 s97, s97, s98
    s_add_u32 s97, s97, 1110016
    v_mov_b32 v48, s96
    v_mov_b32 v49, 0
    s_mov_b64 exec, 1
    buffer_store_dword v48, v49, s[20:23], s97 offen
    buffer_store_dword v48, v49, s[20:23], s97 offen offset:2048 sc1
    s_mov_b64 exec, -1
L_skip_4:
    ds_read_b128 v[64:67], v12 offset:0
    ds_read_b128 v[68:71], v13 offset:0
    ds_read_b128 v[72:75], v14 offset:0
    ds_read_b128 v[76:79], v15 offset:0
    ds_read_b128 v[80:83], v12 offset:4096
    ds_read_b128 v[84:87], v13 offset:4096
    ds_read_b128 v[88:91], v14 offset:4096
    ds_read_b128 v[92:95], v15 offset:4096
    ds_read_b128 v[96:99], v12 offset:8192
    ds_read_b128 v[100:103], v13 offset:8192
    ds_read_b128 v[104:107], v14 offset:8192
    ds_read_b128 v[108:111], v15 offset:8192
    ds_read_b128 v[112:115], v12 offset:12288
    ds_read_b128 v[116:119], v13 offset:12288
    ds_read_b128 v[120:123], v14 offset:12288
    ds_read_b128 v[124:127], v15 offset:12288
    s_waitcnt lgkmcnt(0)
    s_lshl_b32 s97, s32, 7
    s_add_u32 s97, s97, 1110016
    s_add_u32 s98, s97, 2048
    s_lshl_b32 s96, s32, 12
    s_add_u32 s19, s96, 983040
    s_add_u32 s96, s96, 1015808
    s_mov_b32 s99, 64
    buffer_load_dword v60, v56, s[20:23], s97 offen sc1
    buffer_load_dwordx4 v[24:27], v16, s[20:23], s19 offen sc1
    s_sleep 8
    buffer_load_dword v60, v56, s[20:23], s97 offen sc1
    buffer_load_dwordx4 v[24:27], v16, s[20:23], s19 offen sc1
    s_sleep 8
L_poll_5:
    buffer_load_dword v60, v56, s[20:23], s97 offen sc1
    buffer_load_dwordx4 v[24:27], v16, s[20:23], s19 offen sc1
    s_sub_u32 s37, s37, 1
    s_cmp_lt_i32 s37, 0
    s_cbranch_scc1 L_pdone_6
    s_sub_u32 s99, s99, 1
    s_cselect_b32 s97, s98, s97
    s_cselect_b32 s19, s96, s19
    s_sleep 8
    s_waitcnt vmcnt(4)
    v_max_u32 v48, v60, v27
    v_cmp_eq_u32 vcc, -1, v48
    s_cbranch_vccnz L_poll_5
L_pdone_6:
    s_getreg_b32 s96, hwreg(HW_REG_XCC_ID, 0, 4)
    v_cmp_ne_u32 vcc, s96, v60
    s_nop 1
    s_cmp_eq_u64 vcc, 0
    s_cselect_b32 s36, 1, 0
    v_mov_b32 v48, 132608
    v_mov_b32 v49, s36
    ds_write_b32 v48, v49
    s_add_u32 m0, s16, 0
    s_add_u32 s96, s15, 0
    buffer_load_dwordx4 v8, s[8:11], s96 offen offset:0 nt lds
    buffer_load_dwordx4 v9, s[8:11], s96 offen offset:1024 nt lds
    buffer_load_dwordx4 v10, s[8:11], s96 offen offset:2048 nt lds
    buffer_load_dwordx4 v11, s[8:11], s96 offen offset:3072 nt lds
    s_branch L_k_q
L_k_again:
    v_mov_b64 v[32:33], 0
    v_mov_b64 v[34:35], 0
    v_mov_b64 v[36:37], 0
    v_mov_b64 v[38:39], 0
    v_mov_b64 v[40:41], 0
    v_mov_b64 v[42:43], 0
    v_mov_b64 v[44:45], 0
    v_mov_b64 v[46:47], 0
L_poll_7:
    buffer_load_dwordx4 v[24:27], v16, s[20:23], s19 offen sc1
    s_sub_u32 s37, s37, 1
    s_cmp_lt_i32 s37, 0
    s_cbranch_scc1 L_pdone_8
    s_waitcnt vmcnt(0)
    v_cmp_eq_u32 vcc, -1, v27
    s_cbranch_vccnz L_poll_7
L_pdone_8:
    s_branch L_k_q
L_k_l1:
    s_waitcnt vmcnt(0)
    ds_read_b128 v[64:67], v12 offset:0
    ds_read_b128 v[68:71], v13 offset:0
    ds_read_b128 v[72:75], v14 offset:0
    ds_read_b128 v[76:79], v15 offset:0
    ds_read_b128 v[80:83], v12 offset:4096
    ds_read_b128 v[84:87], v13 offset:4096
    ds_read_b128 v[88:91], v14 offset:4096
    ds_read_b128 v[92:95], v15 offset:4096
    ds_read_b128 v[96:99], v12 offset:8192
    ds_read_b128 v[100:103], v13 offset:8192
    ds_read_b128 v[104:107], v14 offset:8192
    ds_read_b128 v[108:111], v15 offset:8192
    ds_read_b128 v[112:115], v12 offset:12288
    ds_read_b128 v[116:119], v13 offset:12288
    ds_read_b128 v[120:123], v14 offset:12288
    ds_read_b128 v[124:127], v15 offset:12288
    s_waitcnt lgkmcnt(0)
    s_sleep 12
    buffer_load_dwordx4 v[192:195], v17, s[20:23], s35 offen sc1
    buffer_load_dwordx4 v[24:27], v16, s[20:23], s19 offen sc1
    s_sleep 2
    buffer_load_dwordx4 v[192:195], v17, s[20:23], s35 offen sc1
    buffer_load_dwordx4 v[24:27], v16, s[20:23], s19 offen sc1
    s_sleep 2
L_poll_9:
    buffer_load_dwordx4 v[192:195], v17, s[20:23], s35 offen sc1
    buffer_load_dwordx4 v[24:27], v16, s[20:23], s19 offen sc1
    s_sub_u32 s37, s37, 1
    s_cmp_lt_i32 s37, 0
    s_cbranch_scc1 L_pdone_10
    s_sleep 2
    s_waitcnt vmcnt(4)
    v_max3_u32 v48, v192, v193, v194
    v_max3_u32 v48, v195, v27, v48
    v_cmp_eq_u32 vcc, -1, v48
    s_cbranch_vccnz L_poll_9
L_pdone_10:
    s_branch L_k_q
L_k_loop:
    s_mov_b32 s19, s35
    s_waitcnt vmcnt(0)
    v_mov_b64 v[32:33], 0
    v_mov_b64 v[34:35], 0
    v_mov_b64 v[36:37], 0
    v_mov_b64 v[38:39], 0
    v_mov_b64 v[40:41], 0
    v_mov_b64 v[42:43], 0
    v_mov_b64 v[44:45], 0
    v_mov_b64 v[46:47], 0
    s_cmp_eq_u32 s34, 1
    s_cbranch_scc1 L_k_l1
    s_sleep 21
    v_mov_b64 v[192:193], -1
    v_mov_b64 v[194:195], -1
    buffer_load_dwordx4 v[24:27], v16, s[20:23], s19 offen sc1
    s_mov_b64 exec, 1
    buffer_load_dwordx4 v[192:195], v17, s[20:23], s35 offen sc1
    s_mov_b64 exec, -1
L_k_top:
    buffer_load_dwordx4 v[24:27], v16, s[20:23], s19 offen sc1
    s_mov_b64 exec, 1
    buffer_load_dwordx4 v[192:195], v17, s[20:23], s35 offen sc1
    s_mov_b64 exec, -1
    s_sub_u32 s37, s37, 1
    s_cmp_lt_i32 s37, 0
    s_cbranch_scc1 L_k_q2
    v_mov_b64 v[32:33], 0
    v_mov_b64 v[34:35], 0
    s_nop 0
    s_waitcnt vmcnt(3)
L_k_q:
    v_cmp_eq_u32 vcc, -1, v27
    v_smfmac_f32_16x16x64_bf16 v[32:35], v[24:27], v[64:71], v21
    v_mov_b32_dpp v28, v24 row_ror:8 row_mask:0xf bank_mask:0xf
    s_cbranch_vccnz L_k_top
L_k_q2:
    v_smfmac_f32_16x16x64_bf16 v[36:39], v[24:27], v[88:95], v21
    v_mov_b32_dpp v29, v25 row_ror:8 row_mask:0xf bank_mask:0xf
    v_smfmac_f32_16x16x64_bf16 v[40:43], v[24:27], v[96:103], v21
    v_mov_b32_dpp v30, v26 row_ror:8 row_mask:0xf bank_mask:0xf
    v_smfmac_f32_16x16x64_bf16 v[44:47], v[24:27], v[120:127], v21
    v_mov_b32_dpp v31, v27 row_ror:8 row_mask:0xf bank_mask:0xf
    s_nop 1
    v_smfmac_f32_16x16x64_bf16 v[32:35], v[28:31], v[72:79], v21
    v_smfmac_f32_16x16x64_bf16 v[36:39], v[28:31], v[80:87], v21
    v_smfmac_f32_16x16x64_bf16 v[40:43], v[28:31], v[104:111], v21
    s_nop 0
    v_add_f32 v48, v32, v33
    v_smfmac_f32_16x16x64_bf16 v[44:47], v[28:31], v[112:119], v21
    s_nop 1
    v_add_f32 v49, v34, v35
    v_add_f32_dpp v48, v36, v37 quad_perm:[0,1,2,3] row_mask:0xc bank_mask:0xf
    v_add_f32_dpp v49, v38, v39 quad_perm:[0,1,2,3] row_mask:0xc bank_mask:0xf
    v_add_f32 v204, v40, v41
    v_add_f32 v205, v42, v43
    v_add_f32 v50, v48, v49
    v_add_f32_dpp v204, v44, v45 quad_perm:[0,1,2,3] row_mask:0xc bank_mask:0xf
    v_add_f32_dpp v205, v46, v47 quad_perm:[0,1,2,3] row_mask:0xc bank_mask:0xf
    v_add_f32 v51, v204, v205
    v_max_f32 v52, v50, v51
    v_pk_add_f32 v[196:197], v[192:193], v[194:195]
    v_pk_mul_f32 v[196:197], v[196:197], s[40:41]
    v_max_f32_dpp v52, v52, v52 quad_perm:[1,0,3,2] row_mask:0xf bank_mask:0xf
    v_fma_f32 v196, -v196, v196, v197
    v_add_f32 v196, |v196|, s42
    v_max_f32_dpp v52, v52, v52 quad_perm:[2,3,0,1] row_mask:0xf bank_mask:0xf
    v_rsq_f32 v196, v196
    s_nop 0
    v_max_f32_dpp v52, v52, v52 row_ror:4 row_mask:0xf bank_mask:0xf
    v_readfirstlane_b32 s17, v196
    s_nop 0
    v_max_f32_dpp v53, v52, v52 row_ror:8 row_mask:0xf bank_mask:0xf
    v_max_f32_dpp v52, v52, v52 row_ror:8 row_mask:0xf bank_mask:0xf
    s_nop 1
    v_permlane32_swap_b32 v52, v53
    v_max_f32 v52, v52, v53
L_k_ok:
    v_pk_add_f32 v[56:57], v[50:51], v[52:53] op_sel_hi:[1,0] neg_lo:[0,1] neg_hi:[0,1]
    v_pk_mul_f32 v[56:57], v[56:57], s[16:17] op_sel:[0,1]
    v_exp_f32 v56, v56
    v_mul_f32 v58, s17, v52
    v_exp_f32 v57, v57
    ds_write_b32 v19, v58
    v_cvt_pk_bf16_f32 v48, v56, v57
    ds_write_b32 v18, v48
    v_cmp_u_f32 vcc, v56, v57
    v_add_f32 v59, v56, v57
    s_cbranch_vccnz L_k_fix
L_k_on:
    s_setprio 2
    s_waitcnt lgkmcnt(0)
    s_barrier
    v_add_f32_dpp v59, v59, v59 quad_perm:[1,0,3,2] row_mask:0xf bank_mask:0xf
    s_cmp_eq_u32 s36, 0
    s_nop 0
    v_add_f32_dpp v59, v59, v59 quad_perm:[2,3,0,1] row_mask:0xf bank_mask:0xf
    ds_read_b128 v[200:203], v22
    s_nop 0
    v_add_f32_dpp v59, v59, v59 row_ror:4 row_mask:0xf bank_mask:0xf
    s_nop 1
    v_add_f32_dpp v53, v59, v59 row_ror:8 row_mask:0xf bank_mask:0xf
    v_add_f32_dpp v59, v59, v59 row_ror:8 row_mask:0xf bank_mask:0xf
    s_nop 1
    v_permlane32_swap_b32 v59, v53
    v_add_f32 v59, v59, v53
    s_mov_b64 exec, 0x10001
    s_waitcnt lgkmcnt(0)
    v_max3_f32 v206, v200, v201, v202
    v_max_f32 v206, v206, v203
    v_sub_f32 v58, v58, v206
    v_exp_f32 v58, v58
    s_cbranch_scc1 L_sg_11
    v_mul_f32 v207, v59, v58
    buffer_store_dwordx2 v[206:207], v20, s[20:23], s35 offen
L_se_12:
    s_mov_b64 exec, -1
    s_setprio 0
    s_cmp_eq_u32 s34, 3
    s_cbranch_scc1 L_k_end
    s_barrier
    s_cmp_eq_u32 s34, 0
    s_cbranch_scc0 L_k_swap
    s_add_u32 m0, s16, 4096
    s_add_u32 s96, s15, 65536
    buffer_load_dwordx4 v8, s[8:11], s96 offen offset:0 nt lds
    buffer_load_dwordx4 v9, s[8:11], s96 offen offset:1024 nt lds
    buffer_load_dwordx4 v10, s[8:11], s96 offen offset:2048 nt lds
    buffer_load_dwordx4 v11, s[8:11], s96 offen offset:3072 nt lds
    s_add_u32 m0, s16, 8192
    s_add_u32 s96, s15, 131072
    buffer_load_dwordx4 v8, s[8:11], s96 offen offset:0 nt lds
    buffer_load_dwordx4 v9, s[8:11], s96 offen offset:1024 nt lds
    buffer_load_dwordx4 v10, s[8:11], s96 offen offset:2048 nt lds
    buffer_load_dwordx4 v11, s[8:11], s96 offen offset:3072 nt lds
    s_add_u32 m0, s16, 12288
    s_add_u32 s96, s15, 196608
    buffer_load_dwordx4 v8, s[8:11], s96 offen offset:0 nt lds
    buffer_load_dwordx4 v9, s[8:11], s96 offen offset:1024 nt lds
    buffer_load_dwordx4 v10, s[8:11], s96 offen offset:2048 nt lds
    buffer_load_dwordx4 v11, s[8:11], s96 offen offset:3072 nt lds
    v_mov_b64 v[128:129], v[64:65]
    v_mov_b64 v[130:131], v[66:67]
    v_mov_b64 v[132:133], v[68:69]
    v_mov_b64 v[134:135], v[70:71]
    v_mov_b64 v[136:137], v[72:73]
    v_mov_b64 v[138:139], v[74:75]
    v_mov_b64 v[140:141], v[76:77]
    v_mov_b64 v[142:143], v[78:79]
    v_mov_b64 v[144:145], v[80:81]
    v_mov_b64 v[146:147], v[82:83]
    v_mov_b64 v[148:149], v[84:85]
    v_mov_b64 v[150:151], v[86:87]
    v_mov_b64 v[152:153], v[88:89]
    v_mov_b64 v[154:155], v[90:91]
    v_mov_b64 v[156:157], v[92:93]
    v_mov_b64 v[158:159], v[94:95]
    v_mov_b64 v[160:161], v[96:97]
    v_mov_b64 v[162:163], v[98:99]
    v_mov_b64 v[164:165], v[100:101]
    v_mov_b64 v[166:167], v[102:103]
    v_mov_b64 v[168:169], v[104:105]
    v_mov_b64 v[170:171], v[106:107]
    v_mov_b64 v[172:173], v[108:109]
    v_mov_b64 v[174:175], v[110:111]
    v_mov_b64 v[176:177], v[112:113]
    v_mov_b64 v[178:179], v[114:115]
    v_mov_b64 v[180:181], v[116:117]
    v_mov_b64 v[182:183], v[118:119]
    v_mov_b64 v[184:185], v[120:121]
    v_mov_b64 v[186:187], v[122:123]
    v_mov_b64 v[188:189], v[124:125]
    v_mov_b64 v[190:191], v[126:127]
    s_branch L_k_next
L_k_swap:
    v_swap_b32 v128, v64
    v_swap_b32 v129, v65
    v_swap_b32 v130, v66
    v_swap_b32 v131, v67
    v_swap_b32 v132, v68
    v_swap_b32 v133, v69
    v_swap_b32 v134, v70
    v_swap_b32 v135, v71
    v_swap_b32 v136, v72
    v_swap_b32 v137, v73
    v_swap_b32 v138, v74
    v_swap_b32 v139, v75
    v_swap_b32 v140, v76
    v_swap_b32 v141, v77
    v_swap_b32 v142, v78
    v_swap_b32 v143, v79
    v_swap_b32 v144, v80
    v_swap_b32 v145, v81
    v_swap_b32 v146, v82
    v_swap_b32 v147, v83
    v_swap_b32 v148, v84
    v_swap_b32 v149, v85
    v_swap_b32 v150, v86
    v_swap_b32 v151, v87
    v_swap_b32 v152, v88
    v_swap_b32 v153, v89
    v_swap_b32 v154, v90
    v_swap_b32 v155, v91
    v_swap_b32 v156, v92
    v_swap_b32 v157, v93
    v_swap_b32 v158, v94
    v_swap_b32 v159, v95
    v_swap_b32 v160, v96
    v_swap_b32 v161, v97
    v_swap_b32 v162, v98
    v_swap_b32 v163, v99
    v_swap_b32 v164, v100
    v_swap_b32 v165, v101
    v_swap_b32 v166, v102
    v_swap_b32 v167, v103
    v_swap_b32 v168, v104
    v_swap_b32 v169, v105
    v_swap_b32 v170, v106
    v_swap_b32 v171, v107
    v_swap_b32 v172, v108
    v_swap_b32 v173, v109
    v_swap_b32 v174, v110
    v_swap_b32 v175, v111
    v_swap_b32 v176, v112
    v_swap_b32 v177, v113
    v_swap_b32 v178, v114
    v_swap_b32 v179, v115
    v_swap_b32 v180, v116
    v_swap_b32 v181, v117
    v_swap_b32 v182, v118
    v_swap_b32 v183, v119
    v_swap_b32 v184, v120
    v_swap_b32 v185, v121
    v_swap_b32 v186, v122
    v_swap_b32 v187, v123
    v_swap_b32 v188, v124
    v_swap_b32 v189, v125
    v_swap_b32 v190, v126
    v_swap_b32 v191, v127
L_k_next:
    s_add_u32 s34, s34, 1
    s_add_u32 s35, s35, 16384
    s_branch L_k_loop
L_k_end:
    s_endpgm
L_v:
    s_mul_i32 s96, s18, 12288
    s_sub_u32 s16, s16, s96
    s_and_b32 s96, s18, 1
    s_mul_i32 s96, s96, 61440
    s_add_u32 s15, s15, s96
    s_lshr_b32 s96, s18, 1
    s_mul_i32 s97, s96, 122880
    s_add_u32 s15, s15, s97
    s_lshl_b32 s96, s96, 7
    v_xor_b32 v8, s96, v8
    v_xor_b32 v9, s96, v9
    v_mov_b32 v48, 132608
    v_mov_b64 v[50:51], 0
    v_mov_b64 v[52:53], 0
    ds_write_b128 v48, v[50:53]
    ds_write_b128 v48, v[50:53] offset:16
    ds_write_b128 v48, v[50:53] offset:32
    ds_write_b128 v48, v[50:53] offset:128
    v_bfe_u32 v5, v1, 2, 1
    v_bfe_u32 v6, v1, 3, 1
    v_and_b32 v7, 1, v4
    v_lshlrev_b32 v48, 5, v5
    v_and_b32 v49, 2, v4
    v_lshl_add_u32 v48, v49, 2, v48
    v_lshl_add_u32 v48, v6, 2, v48
    v_lshl_add_u32 v48, v7, 1, v48
    v_lshl_add_u32 v49, v6, 1, v7
    v_lshl_add_u32 v49, v5, 2, v49
    s_lshl_b32 s96, s18, 1
    v_xor_b32 v49, s96, v49
    v_lshlrev_b32 v48, 8, v48
    v_lshl_add_u32 v48, v49, 5, v48
    v_and_b32 v49, 3, v1
    v_lshl_add_u32 v48, v49, 3, v48
    v_add_u32 v12, 0x10000, v48
    v_xor_b32 v13, 32, v12
    v_lshlrev_b32 v14, 4, v1
    v_add_u32 v14, 131072, v14
    v_lshlrev_b32 v15, 2, v4
    v_add_u32 v15, 132096, v15
    v_mov_b32 v16, 132096
    v_and_b32 v48, 10, v1
    v_mov_b32 v49, 132736
    v_mov_b32 v50, 132640
    v_cmp_eq_u32 vcc, 0, v48
    s_nop 1
    v_cndmask_b32 v36, v49, v14, vcc
    v_cmp_eq_u32 vcc, 2, v48
    s_nop 1
    v_cndmask_b32 v37, v49, v14, vcc
    v_cmp_eq_u32 vcc, 8, v48
    s_nop 1
    v_cndmask_b32 v38, v50, v14, vcc
    v_cmp_eq_u32 vcc, 10, v48
    s_nop 1
    v_cndmask_b32 v39, v50, v14, vcc
    v_lshl_add_u32 v16, v7, 4, v16
    v_and_b32 v48, 2, v4
    v_lshl_add_u32 v15, v48, 2, v16
    s_lshl_b32 s96, s12, 12
    s_lshl_b32 s97, s18, 9
    s_add_u32 s96, s96, s97
    s_and_b32 s97, s33, 7
    s_lshl_b32 s97, s97, 4
    s_add_u32 s96, s96, s97
    s_add_u32 s96, s96, 4096
    v_lshlrev_b32 v17, 11, v7
    v_lshrrev_b32 v48, 1, v4
    v_lshl_add_u32 v17, v48, 8, v17
    v_lshl_add_u32 v17, v6, 7, v17
    v_and_b32 v48, 7, v1
    v_lshl_add_u32 v17, v48, 1, v17
    v_add_u32 v17, s96, v17
    s_lshl_b32 s96, s18, 2
    s_add_u32 s96, s96, 132624
    v_mov_b32 v18, s96
    v_mov_b32 v19, 132624
    v_and_b32 v5, 1, v1
    v_mul_u32_u24 v21, 0xaaaa, v5
    v_add_u32 v21, 0x4444, v21
    s_waitcnt lgkmcnt(0)
    s_barrier
    s_add_u32 m0, s16, 0
    s_add_u32 s96, s15, 0
    buffer_load_dwordx4 v8, s[4:7], s96 offen offset:0 nt lds
    buffer_load_dwordx4 v9, s[4:7], s96 offen offset:1024 nt lds
    buffer_load_dwordx4 v8, s[4:7], s96 offen offset:2048 nt lds
    buffer_load_dwordx4 v9, s[4:7], s96 offen offset:3072 nt lds
    s_add_u32 m0, s16, 16384
    s_add_u32 s96, s15, 4096
    buffer_load_dwordx4 v8, s[4:7], s96 offen offset:0 nt lds
    buffer_load_dwordx4 v9, s[4:7], s96 offen offset:1024 nt lds
    buffer_load_dwordx4 v8, s[4:7], s96 offen offset:2048 nt lds
    buffer_load_dwordx4 v9, s[4:7], s96 offen offset:3072 nt lds
    s_add_u32 m0, s16, 32768
    s_add_u32 s96, s15, 8192
    buffer_load_dwordx4 v8, s[4:7], s96 offen offset:0 nt lds
    buffer_load_dwordx4 v9, s[4:7], s96 offen offset:1024 nt lds
    buffer_load_dwordx4 v8, s[4:7], s96 offen offset:2048 nt lds
    buffer_load_dwordx4 v9, s[4:7], s96 offen offset:3072 nt lds
    s_add_u32 m0, s16, 49152
    s_add_u32 s96, s15, 12288
    buffer_load_dwordx4 v8, s[4:7], s96 offen offset:0 nt lds
    buffer_load_dwordx4 v9, s[4:7], s96 offen offset:1024 nt lds
    buffer_load_dwordx4 v8, s[4:7], s96 offen offset:2048 nt lds
    buffer_load_dwordx4 v9, s[4:7], s96 offen offset:3072 nt lds
L_v_loop:
    v_mov_b64 v[192:193], 0
    v_mov_b64 v[194:195], 0
    v_mov_b64 v[196:197], 0
    v_mov_b64 v[198:199], 0
    s_cmp_lt_u32 s34, 2
    s_cbranch_scc0 L_skip_14
    s_lshl2_add_u32 s96, s34, 1
    v_mov_b32 v48, s96
    s_waitcnt vmcnt(12)
    ds_write_b32 v18, v48
L_vf_15:
    ds_read_b128 v[52:55], v19
    s_sub_u32 s37, s37, 1
    s_cmp_lt_i32 s37, 0
    s_waitcnt lgkmcnt(0)
    s_cbranch_scc1 L_vfd_16
    v_min3_u32 v49, v52, v53, v54
    v_min_u32 v49, v49, v55
    v_cmp_gt_u32 vcc, s96, v49
    s_cbranch_vccnz L_vf_15
L_vfd_16:
    ds_read_b64_tr_b16 v[64:65], v12 offset:0
    ds_read_b64_tr_b16 v[66:67], v12 offset:256
    ds_read_b64_tr_b16 v[68:69], v12 offset:4096
    ds_read_b64_tr_b16 v[70:71], v12 offset:4352
    ds_read_b64_tr_b16 v[72:73], v13 offset:0
    ds_read_b64_tr_b16 v[74:75], v13 offset:256
    ds_read_b64_tr_b16 v[76:77], v13 offset:4096
    ds_read_b64_tr_b16 v[78:79], v13 offset:4352
    s_lshl2_add_u32 s96, s34, 2
    v_mov_b32 v48, s96
    s_waitcnt vmcnt(8)
    ds_write_b32 v18, v48
L_vf_17:
    ds_read_b128 v[52:55], v19
    s_sub_u32 s37, s37, 1
    s_cmp_lt_i32 s37, 0
    s_waitcnt lgkmcnt(0)
    s_cbranch_scc1 L_vfd_18
    v_min3_u32 v49, v52, v53, v54
    v_min_u32 v49, v49, v55
    v_cmp_gt_u32 vcc, s96, v49
    s_cbranch_vccnz L_vf_17
L_vfd_18:
    ds_read_b64_tr_b16 v[80:81], v12 offset:16384
    ds_read_b64_tr_b16 v[82:83], v12 offset:16640
    ds_read_b64_tr_b16 v[84:85], v12 offset:20480
    ds_read_b64_tr_b16 v[86:87], v12 offset:20736
    ds_read_b64_tr_b16 v[88:89], v13 offset:16384
    ds_read_b64_tr_b16 v[90:91], v13 offset:16640
    ds_read_b64_tr_b16 v[92:93], v13 offset:20480
    ds_read_b64_tr_b16 v[94:95], v13 offset:20736
    s_lshl2_add_u32 s96, s34, 3
    v_mov_b32 v48, s96
    s_waitcnt vmcnt(4)
    ds_write_b32 v18, v48
L_vf_19:
    ds_read_b128 v[52:55], v19
    s_sub_u32 s37, s37, 1
    s_cmp_lt_i32 s37, 0
    s_waitcnt lgkmcnt(0)
    s_cbranch_scc1 L_vfd_20
    v_min3_u32 v49, v52, v53, v54
    v_min_u32 v49, v49, v55
    v_cmp_gt_u32 vcc, s96, v49
    s_cbranch_vccnz L_vf_19
L_vfd_20:
    ds_read_b64_tr_b16 v[96:97], v12 offset:32768
    ds_read_b64_tr_b16 v[98:99], v12 offset:33024
    ds_read_b64_tr_b16 v[100:101], v12 offset:36864
    ds_read_b64_tr_b16 v[102:103], v12 offset:37120
    ds_read_b64_tr_b16 v[104:105], v13 offset:32768
    ds_read_b64_tr_b16 v[106:107], v13 offset:33024
    ds_read_b64_tr_b16 v[108:109], v13 offset:36864
    ds_read_b64_tr_b16 v[110:111], v13 offset:37120
    s_lshl2_add_u32 s96, s34, 4
    v_mov_b32 v48, s96
    s_waitcnt vmcnt(0)
    ds_write_b32 v18, v48
L_vf_21:
    ds_read_b128 v[52:55], v19
    s_sub_u32 s37, s37, 1
    s_cmp_lt_i32 s37, 0
    s_waitcnt lgkmcnt(0)
    s_cbranch_scc1 L_vfd_22
    v_min3_u32 v49, v52, v53, v54
    v_min_u32 v49, v49, v55
    v_cmp_gt_u32 vcc, s96, v49
    s_cbranch_vccnz L_vf_21
L_vfd_22:
    ds_read_b64_tr_b16 v[112:113], v12 offset:49152
    ds_read_b64_tr_b16 v[114:115], v12 offset:49408
    ds_read_b64_tr_b16 v[116:117], v12 offset:53248
    ds_read_b64_tr_b16 v[118:119], v12 offset:53504
    ds_read_b64_tr_b16 v[120:121], v13 offset:49152
    ds_read_b64_tr_b16 v[122:123], v13 offset:49408
    ds_read_b64_tr_b16 v[124:125], v13 offset:53248
    ds_read_b64_tr_b16 v[126:127], v13 offset:53504
    v_mov_b32 v56, 132608
    ds_read_b32 v57, v56
    s_waitcnt lgkmcnt(0)
    v_readfirstlane_b32 s36, v57
    s_nop 4
L_skip_14:
    s_setprio 1
    s_cmp_eq_u32 s36, 0
    s_barrier
    ds_read_b128 v[208:211], v36
    ds_read_b128 v[212:215], v37
    ds_read_b128 v[216:219], v38
    ds_read_b128 v[220:223], v39
    ds_read_b128 v[28:31], v16
    ds_read_b64 v[22:23], v15
    s_waitcnt lgkmcnt(5)
    v_smfmac_f32_16x16x64_bf16 v[192:195], v[208:211], v[64:71], v21
    s_waitcnt lgkmcnt(4)
    v_smfmac_f32_16x16x64_bf16 v[192:195], v[212:215], v[80:87], v21
    s_waitcnt lgkmcnt(3)
    v_smfmac_f32_16x16x64_bf16 v[192:195], v[216:219], v[96:103], v21
    s_waitcnt lgkmcnt(2)
    v_smfmac_f32_16x16x64_bf16 v[192:195], v[220:223], v[112:119], v21
    s_waitcnt lgkmcnt(0)
    v_max3_f32 v54, v28, v29, v30
    v_smfmac_f32_16x16x64_bf16 v[196:199], v[208:211], v[72:79], v21
    v_max_f32 v54, v54, v31
    v_smfmac_f32_16x16x64_bf16 v[196:199], v[212:215], v[88:95], v21
    v_sub_f32 v52, v22, v54
    v_smfmac_f32_16x16x64_bf16 v[196:199], v[216:219], v[104:111], v21
    v_sub_f32 v53, v23, v54
    v_smfmac_f32_16x16x64_bf16 v[196:199], v[220:223], v[120:127], v21
    s_nop 1
    v_exp_f32 v52, v52
    v_add_f32 v48, v192, v193
    v_exp_f32 v53, v53
    v_add_f32 v49, v194, v195
    v_mul_f32 v48, v48, v52
    v_fmac_f32 v48, v49, v53
    v_pk_mul_f32 v[50:51], v[196:197], v[52:53] op_sel_hi:[1,0]
    v_pk_fma_f32 v[50:51], v[198:199], v[52:53], v[50:51] op_sel:[0,1,0]
    v_add_f32 v50, v50, v51
    s_cbranch_scc1 L_sg_23
L_sf_25:
    s_nop 0
    v_permlane32_swap_b32 v48, v50
    v_add_f32 v48, v48, v50
    v_cvt_pk_bf16_f32 v48, v48, v48
    buffer_store_short v48, v17, s[20:23], s35 offen
L_se_24:
    s_setprio 0
    s_cmp_eq_u32 s34, 3
    s_cbranch_scc1 L_v_end
    s_barrier
    s_cmp_eq_u32 s34, 0
    s_cbranch_scc0 L_v_swap
    s_add_u32 m0, s16, 0
    s_add_u32 s96, s15, 0
    buffer_load_dwordx4 v8, s[8:11], s96 offen offset:0 nt lds
    buffer_load_dwordx4 v9, s[8:11], s96 offen offset:1024 nt lds
    buffer_load_dwordx4 v8, s[8:11], s96 offen offset:2048 nt lds
    buffer_load_dwordx4 v9, s[8:11], s96 offen offset:3072 nt lds
    s_add_u32 m0, s16, 16384
    s_add_u32 s96, s15, 4096
    buffer_load_dwordx4 v8, s[8:11], s96 offen offset:0 nt lds
    buffer_load_dwordx4 v9, s[8:11], s96 offen offset:1024 nt lds
    buffer_load_dwordx4 v8, s[8:11], s96 offen offset:2048 nt lds
    buffer_load_dwordx4 v9, s[8:11], s96 offen offset:3072 nt lds
    s_add_u32 m0, s16, 32768
    s_add_u32 s96, s15, 8192
    buffer_load_dwordx4 v8, s[8:11], s96 offen offset:0 nt lds
    buffer_load_dwordx4 v9, s[8:11], s96 offen offset:1024 nt lds
    buffer_load_dwordx4 v8, s[8:11], s96 offen offset:2048 nt lds
    buffer_load_dwordx4 v9, s[8:11], s96 offen offset:3072 nt lds
    s_add_u32 m0, s16, 49152
    s_add_u32 s96, s15, 12288
    buffer_load_dwordx4 v8, s[8:11], s96 offen offset:0 nt lds
    buffer_load_dwordx4 v9, s[8:11], s96 offen offset:1024 nt lds
    buffer_load_dwordx4 v8, s[8:11], s96 offen offset:2048 nt lds
    buffer_load_dwordx4 v9, s[8:11], s96 offen offset:3072 nt lds
    v_mov_b64 v[128:129], v[64:65]
    v_mov_b64 v[130:131], v[66:67]
    v_mov_b64 v[132:133], v[68:69]
    v_mov_b64 v[134:135], v[70:71]
    v_mov_b64 v[136:137], v[72:73]
    v_mov_b64 v[138:139], v[74:75]
    v_mov_b64 v[140:141], v[76:77]
    v_mov_b64 v[142:143], v[78:79]
    v_mov_b64 v[144:145], v[80:81]
    v_mov_b64 v[146:147], v[82:83]
    v_mov_b64 v[148:149], v[84:85]
    v_mov_b64 v[150:151], v[86:87]
    v_mov_b64 v[152:153], v[88:89]
    v_mov_b64 v[154:155], v[90:91]
    v_mov_b64 v[156:157], v[92:93]
    v_mov_b64 v[158:159], v[94:95]
    v_mov_b64 v[160:161], v[96:97]
    v_mov_b64 v[162:163], v[98:99]
    v_mov_b64 v[164:165], v[100:101]
    v_mov_b64 v[166:167], v[102:103]
    v_mov_b64 v[168:169], v[104:105]
    v_mov_b64 v[170:171], v[106:107]
    v_mov_b64 v[172:173], v[108:109]
    v_mov_b64 v[174:175], v[110:111]
    v_mov_b64 v[176:177], v[112:113]
    v_mov_b64 v[178:179], v[114:115]
    v_mov_b64 v[180:181], v[116:117]
    v_mov_b64 v[182:183], v[118:119]
    v_mov_b64 v[184:185], v[120:121]
    v_mov_b64 v[186:187], v[122:123]
    v_mov_b64 v[188:189], v[124:125]
    v_mov_b64 v[190:191], v[126:127]
    s_branch L_v_next
L_v_swap:
    v_swap_b32 v128, v64
    v_swap_b32 v129, v65
    v_swap_b32 v130, v66
    v_swap_b32 v131, v67
    v_swap_b32 v132, v68
    v_swap_b32 v133, v69
    v_swap_b32 v134, v70
    v_swap_b32 v135, v71
    v_swap_b32 v136, v72
    v_swap_b32 v137, v73
    v_swap_b32 v138, v74
    v_swap_b32 v139, v75
    v_swap_b32 v140, v76
    v_swap_b32 v141, v77
    v_swap_b32 v142, v78
    v_swap_b32 v143, v79
    v_swap_b32 v144, v80
    v_swap_b32 v145, v81
    v_swap_b32 v146, v82
    v_swap_b32 v147, v83
    v_swap_b32 v148, v84
    v_swap_b32 v149, v85
    v_swap_b32 v150, v86
    v_swap_b32 v151, v87
    v_swap_b32 v152, v88
    v_swap_b32 v153, v89
    v_swap_b32 v154, v90
    v_swap_b32 v155, v91
    v_swap_b32 v156, v92
    v_swap_b32 v157, v93
    v_swap_b32 v158, v94
    v_swap_b32 v159, v95
    v_swap_b32 v160, v96
    v_swap_b32 v161, v97
    v_swap_b32 v162, v98
    v_swap_b32 v163, v99
    v_swap_b32 v164, v100
    v_swap_b32 v165, v101
    v_swap_b32 v166, v102
    v_swap_b32 v167, v103
    v_swap_b32 v168, v104
    v_swap_b32 v169, v105
    v_swap_b32 v170, v106
    v_swap_b32 v171, v107
    v_swap_b32 v172, v108
    v_swap_b32 v173, v109
    v_swap_b32 v174, v110
    v_swap_b32 v175, v111
    v_swap_b32 v176, v112
    v_swap_b32 v177, v113
    v_swap_b32 v178, v114
    v_swap_b32 v179, v115
    v_swap_b32 v180, v116
    v_swap_b32 v181, v117
    v_swap_b32 v182, v118
    v_swap_b32 v183, v119
    v_swap_b32 v184, v120
    v_swap_b32 v185, v121
    v_swap_b32 v186, v122
    v_swap_b32 v187, v123
    v_swap_b32 v188, v124
    v_swap_b32 v189, v125
    v_swap_b32 v190, v126
    v_swap_b32 v191, v127
L_v_next:
    s_add_u32 s34, s34, 1
    s_add_u32 s35, s35, 16384
    s_branch L_v_loop
L_v_end:
    s_endpgm
L_q:
    v_and_b32 v1, 63, v0
    v_and_b32 v3, 15, v1
    v_lshrrev_b32 v4, 4, v1
    s_mov_b32 s22, 268435456
    s_mov_b32 s23, 0x20000
    s_mov_b32 s26, 256
    s_mov_b32 s27, 0x20000
    s_mov_b32 s7, 0x20000
    s_mov_b32 s11, 0x20000
    s_mov_b32 s37, 131072
    s_lshl_b32 s35, s32, 16
    s_mov_b32 s34, 0
    s_mov_b32 s36, 0
    s_mov_b32 s6, 4718592
    s_mov_b32 s10, 4718592
    s_mov_b32 s14, 2304
    s_mov_b32 s15, 0x20000
    s_mov_b32 s30, 2304
    s_mov_b32 s31, 0x20000
    s_and_b32 s100, s33, 7
    s_lshr_b32 s101, s33, 3
    s_mul_i32 s96, s32, 11
    s_lshr_b32 s96, s96, 5
    s_mul_i32 s96, s96, 8704
    s_mul_i32 s39, s32, 2560
    s_add_u32 s39, s39, s96
    v_lshrrev_b32 v5, 3, v1
    v_and_b32 v6, 7, v1
    v_lshrrev_b32 v7, 5, v1
    v_lshlrev_b32 v7, 1, v7
    v_xor_b32 v7, v7, v6
    s_and_b32 s96, s3, 1
    s_lshl_b32 s96, s96, 2
    v_xor_b32 v24, s96, v7
    v_lshlrev_b32 v24, 4, v24
    v_lshl_add_u32 v24, v5, 13, v24
    s_and_b32 s98, s33, 1
    s_mul_i32 s96, s98, 2359296
    s_lshl_b32 s97, s3, 16
    s_add_u32 s96, s96, s97
    s_lshl_b32 s97, s32, 10
    s_add_u32 s96, s96, s97
    s_lshr_b32 s97, s33, 1
    s_xor_b32 s97, s97, 4
    s_lshl_b32 s97, s97, 7
    s_add_u32 s99, s96, s97
    v_bfe_u32 v48, v1, 1, 1
    v_mul_u32_u24 v48, 1152, v48
    v_and_b32 v49, 1, v1
    v_lshl_add_u32 v48, v49, 4, v48
    v_bfe_u32 v49, v1, 2, 2
    v_lshl_add_u32 v50, v4, 5, v48
    v_lshl_add_u32 v50, v49, 7, v50
    v_and_b32 v51, 1, v4
    v_lshl_add_u32 v51, v51, 5, v48
    v_xor_b32 v49, s98, v49
    v_and_b32 v49, 1, v49
    v_mul_u32_u24 v52, 576, v49
    v_add_u32 v51, v51, v52
    s_mul_i32 s96, s98, 576
    s_sub_u32 s97, 576, s96
    v_mov_b64 v[232:233], 0
    v_mov_b64 v[234:235], 0
    v_bfe_u32 v52, v1, 3, 1
    v_and_b32 v53, 1, v1
    v_lshl_add_u32 v31, v52, 1, v53
    v_lshl_add_u32 v31, v4, 2, v31
    v_lshlrev_b32 v31, 4, v31
    v_add_u32 v31, 116736, v31
    v_mul_u32_u24 v52, 1152, v52
    v_lshl_add_u32 v52, v53, 4, v52
    v_lshl_add_u32 v52, v4, 5, v52
    s_waitcnt lgkmcnt(0)
    s_mov_b64 s[4:5], s[54:55]
    s_mov_b64 s[8:9], s[40:41]
    s_cmp_eq_u32 s101, 0
    s_cselect_b64 s[16:17], s[42:43], s[56:57]
    s_mov_b64 s[24:25], s[46:47]
    s_mov_b64 s[12:13], s[48:49]
    s_mov_b64 s[28:29], s[44:45]
    s_mov_b32 s58, s98
    s_lshr_b32 s59, s33, 1
    s_xor_b32 s59, s59, 4
    s_mov_b32 s61, s99
    s_mov_b32 s56, 0x000f000f
    s_mov_b32 s57, 0x00ff00ff
    s_mov_b64 s[62:63], 0
    s_lshl_b32 s98, s3, 10
    s_add_u32 m0, s98, 0
    s_add_u32 s99, s61, 0
    buffer_load_dwordx4 v24, s[4:7], s99 offen nt lds
    s_add_u32 m0, s98, 4096
    s_add_u32 s99, s61, 262144
    buffer_load_dwordx4 v24, s[4:7], s99 offen nt lds
    s_add_u32 m0, s98, 8192
    s_add_u32 s99, s61, 524288
    buffer_load_dwordx4 v24, s[4:7], s99 offen nt lds
    s_add_u32 m0, s98, 12288
    s_add_u32 s99, s61, 786432
    buffer_load_dwordx4 v24, s[4:7], s99 offen nt lds
    s_add_u32 m0, s98, 16384
    s_add_u32 s99, s61, 1048576
    buffer_load_dwordx4 v24, s[4:7], s99 offen nt lds
    s_add_u32 m0, s98, 20480
    s_add_u32 s99, s61, 1310720
    buffer_load_dwordx4 v24, s[4:7], s99 offen nt lds
    s_add_u32 m0, s98, 24576
    s_add_u32 s99, s61, 1572864
    buffer_load_dwordx4 v24, s[4:7], s99 offen nt lds
    s_add_u32 m0, s98, 28672
    s_add_u32 s99, s61, 1835008
    buffer_load_dwordx4 v24, s[4:7], s99 offen nt lds
    s_add_u32 m0, s98, 32768
    s_add_u32 s99, s61, 2097152
    buffer_load_dwordx4 v24, s[4:7], s99 offen nt lds
    buffer_load_dwordx4 v[224:227], v50, s[12:15], s96 offen
    buffer_load_dwordx4 v[228:231], v50, s[12:15], s97 offen
    s_mov_b64 exec, s[56:57]
    buffer_load_dwordx4 v[232:235], v51, s[12:15], 0 offen offset:512
    s_mov_b64 exec, -1
    buffer_load_dwordx4 v[112:115], v52, s[12:15], s96 offen offset:0
    buffer_load_dwordx4 v[116:119], v52, s[12:15], s96 offen offset:128
    buffer_load_dwordx4 v[120:123], v52, s[12:15], s96 offen offset:256
    buffer_load_dwordx4 v[124:127], v52, s[12:15], s96 offen offset:384
    s_mov_b64 s[4:5], s[16:17]
    s_barrier
    v_and_b32 v53, 1, v4
    v_lshlrev_b32 v53, 6, v53
    v_lshl_add_u32 v53, v3, 4, v53
    v_cmp_gt_u32 vcc, 4, v3
    v_mov_b32 v54, 128
    s_nop 0
    v_cndmask_b32 v28, v54, v53, vcc
    v_add_u32 v28, 118016, v28
    s_lshl_b32 s96, s33, 8
    s_lshl_b32 s97, s3, 6
    s_add_u32 s96, s96, s97
    v_lshl_add_u32 v26, v3, 2, s96
    s_lshr_b32 s96, s59, 2
    s_lshl_b32 s96, s96, 11
    s_lshl_b32 s97, s3, 8
    s_add_u32 s96, s96, s97
    s_and_b32 s97, s59, 1
    s_lshl_b32 s97, s97, 7
    s_add_u32 s96, s96, s97
    s_lshl_b32 s97, s58, 5
    s_add_u32 s96, s96, s97
    s_and_b32 s97, s59, 2
    s_lshl_b32 s97, s97, 5
    s_add_u32 s96, s96, s97
    v_and_b32 v30, 1, v1
    v_lshlrev_b32 v29, 1, v30
    v_and_b32 v53, 12, v1
    v_add_u32 v29, v29, v53
    v_bfe_u32 v53, v1, 1, 1
    v_lshl_add_u32 v29, v53, 4, v29
    v_lshrrev_b32 v53, 5, v1
    v_lshl_add_u32 v29, v53, 10, v29
    v_add_u32 v29, s96, v29
    v_mul_u32_u24 v30, 0xaaaa, v30
    v_add_u32 v30, 0x4444, v30
    v_bfe_u32 v48, v1, 2, 1
    v_bfe_u32 v49, v1, 3, 1
    v_and_b32 v50, 1, v4
    v_lshrrev_b32 v51, 1, v4
    v_lshl_add_u32 v56, v51, 4, v48
    v_lshl_add_u32 v56, v50, 2, v56
    v_lshl_add_u32 v56, v49, 3, v56
    v_lshl_add_u32 v57, v49, 1, v50
    v_xor_b32 v57, s3, v57
    v_lshlrev_b32 v25, 7, v56
    v_lshl_add_u32 v25, v57, 5, v25
    v_and_b32 v48, 3, v1
    v_lshl_add_u32 v25, v48, 3, v25
    s_mov_b32 s97, 4
    s_lshl_b32 s96, s100, 7
    s_add_u32 s96, s96, 12288
    v_mov_b32 v12, s96
    s_lshl_b32 s98, s97, 10
    s_add_u32 s98, s98, 110592
    v_and_b32 v48, 31, v1
    v_lshl_add_u32 v8, v48, 5, s98
    v_and_b32 v49, 16, v1
    v_add_u32 v8, v8, v49
    v_xor_b32 v204, 16, v8
    v_and_b32 v49, 7, v48
    v_lshlrev_b32 v49, 1, v49
    v_and_b32 v50, 16, v48
    v_add_u32 v49, v49, v50
    s_lshl_b32 s98, s100, 8
    s_lshl_b32 s99, s97, 6
    s_add_u32 s98, s98, s99
    s_lshl_b32 s99, s100, 5
    s_add_u32 s99, s99, 2048
    s_cmp_eq_u32 s97, 4
    s_cselect_b32 s98, s99, s98
    s_cselect_b32 s99, 0, 8
    s_cselect_b32 s96, 1, 3
    v_and_b32 v50, s99, v48
    v_lshl_add_u32 v49, v50, 2, v49
    s_add_u32 s98, s98, s39
    v_add_u32 v9, s98, v49
    v_lshrrev_b32 v50, 5, v1
    v_lshl_add_u32 v9, v50, 13, v9
    v_lshrrev_b32 v48, 2, v3
    v_and_b32 v48, s96, v48
    v_and_b32 v49, 1, v1
    v_bfe_u32 v50, v1, 1, 1
    v_and_b32 v51, 1, v4
    s_and_b32 s96, s33, 1
    s_mul_i32 s98, s96, 1152
    s_lshl_b32 s99, s97, 8
    s_add_u32 s98, s98, s99
    v_lshl_add_u32 v52, v48, 6, s98
    v_lshl_add_u32 v52, v49, 5, v52
    v_lshl_add_u32 v52, v50, 4, v52
    v_mul_u32_u24 v53, 2560, v4
    v_add_u32 v52, v52, v53
    v_lshrrev_b32 v53, 1, v4
    v_and_b32 v54, v53, v4
    v_mul_u32_u24 v53, 8704, v53
    v_mul_u32_u24 v54, 8704, v54
    v_add_u32 v10, v52, v54
    v_add_u32 v53, 18944, v53
    v_add_u32 v194, v52, v53
    s_lshr_b32 s98, s98, 1
    v_mul_u32_u24 v14, 1152, v50
    v_lshl_add_u32 v14, v48, 5, v14
    v_lshl_add_u32 v14, v49, 4, v14
    v_lshl_add_u32 v14, v51, 3, v14
    v_add_u32 v14, s98, v14
    s_mul_i32 s98, s97, 320
    s_add_u32 s98, s98, 116736
    v_and_b32 v52, 3, v1
    v_lshlrev_b32 v52, 4, v52
    v_lshl_add_u32 v11, v48, 6, v52
    v_lshl_add_u32 v11, v51, 3, v11
    v_add_u32 v11, s98, v11
    v_lshrrev_b32 v48, 2, v3
    v_mul_u32_u24 v48, 320, v48
    v_lshl_add_u32 v48, v4, 6, v48
    v_add_u32 v48, 116736, v48
    v_add_u32 v15, v48, v52
    v_lshlrev_b32 v49, 4, v49
    v_mov_b32 v53, 0x3f80
    v_lshlrev_b32 v53, v49, v53
    v_bfe_u32 v49, v1, 1, 2
    v_cmp_eq_u32 vcc, 0, v49
    s_nop 1
    v_cndmask_b32 v188, 0, v53, vcc
    v_cmp_eq_u32 vcc, 1, v49
    s_nop 1
    v_cndmask_b32 v189, 0, v53, vcc
    v_cmp_eq_u32 vcc, 2, v49
    s_nop 1
    v_cndmask_b32 v190, 0, v53, vcc
    v_cmp_eq_u32 vcc, 3, v49
    s_nop 1
    v_cndmask_b32 v191, 0, v53, vcc
    s_mov_b32 s38, 1048576
    v_mov_b32 v13, 14848
    buffer_load_dwordx2 v[184:185], v14, s[12:15], 0 offen
    s_cmp_eq_u32 s3, 1
    s_cbranch_scc0 L_skip_26
    s_waitcnt vmcnt(16)
    s_load_dwordx4 s[44:47], s[24:25], 0
    s_waitcnt lgkmcnt(0)
    s_and_b64 s[44:45], s[44:45], s[46:47]
    s_and_b32 s44, s44, s45
    s_cmp_eq_u32 s44, -1
    s_cbranch_scc1 L_flagd_27
    s_sleep 8
    s_load_dwordx4 s[44:47], s[24:25], 64
    s_waitcnt lgkmcnt(0)
    s_and_b64 s[44:45], s[44:45], s[46:47]
    s_and_b32 s44, s44, s45
    s_cmp_eq_u32 s44, -1
    s_cbranch_scc1 L_flagd_27
    s_sleep 8
L_poll_28:
    buffer_load_ubyte v58, v3, s[24:27], 0 offen offset:0 sc1
    s_sub_u32 s37, s37, 1
    s_cmp_lt_i32 s37, 0
    s_cbranch_scc1 L_pdone_29
    s_sleep 8
    s_waitcnt vmcnt(0)
    v_cmp_eq_u32 vcc, 0, v58
    s_cbranch_vccnz L_poll_28
L_pdone_29:
L_flagd_27:
    s_nop 3
L_skip_26:
    s_waitcnt vmcnt(0) lgkmcnt(0)
    s_mov_b32 s36, 1
    s_lshl_b32 s55, s32, 12
    s_add_u32 s55, s55, 983040
    s_barrier
    ds_read_b64_tr_b16 v[64:65], v25 offset:0
    ds_read_b64_tr_b16 v[66:67], v25 offset:256
    ds_read_b64_tr_b16 v[68:69], v25 offset:4096
    ds_read_b64_tr_b16 v[70:71], v25 offset:4352
    ds_read_b64_tr_b16 v[72:73], v25 offset:8192
    ds_read_b64_tr_b16 v[74:75], v25 offset:8448
    ds_read_b64_tr_b16 v[76:77], v25 offset:12288
    ds_read_b64_tr_b16 v[78:79], v25 offset:12544
    ds_read_b64_tr_b16 v[80:81], v25 offset:16384
    ds_read_b64_tr_b16 v[82:83], v25 offset:16640
    ds_read_b64_tr_b16 v[84:85], v25 offset:20480
    ds_read_b64_tr_b16 v[86:87], v25 offset:20736
    ds_read_b64_tr_b16 v[88:89], v25 offset:24576
    ds_read_b64_tr_b16 v[90:91], v25 offset:24832
    ds_read_b64_tr_b16 v[92:93], v25 offset:28672
    ds_read_b64_tr_b16 v[94:95], v25 offset:28928
    ds_read_b64_tr_b16 v[96:97], v25 offset:32768
    ds_read_b64_tr_b16 v[98:99], v25 offset:33024
    v_mov_b64 v[100:101], 0
    v_mov_b64 v[102:103], 0
    v_mov_b64 v[104:105], 0
    v_mov_b64 v[106:107], 0
    v_mov_b64 v[160:161], 0
    v_mov_b64 v[162:163], 0
    v_mov_b64 v[164:165], 0
    v_mov_b64 v[166:167], 0
    v_mov_b64 v[168:169], 0
    v_mov_b64 v[170:171], 0
    v_mov_b64 v[172:173], 0
    v_mov_b64 v[174:175], 0
    v_mov_b64 v[176:177], 0
    v_mov_b64 v[178:179], 0
    v_mov_b64 v[216:217], 0
    v_mov_b64 v[218:219], 0
    v_mov_b32 v48, 0x3f803f80
    v_mov_b32 v208, v48
    v_mov_b32 v209, v48
    v_mov_b32 v210, v48
    v_mov_b32 v211, v48
    v_mov_b64 v[32:33], v[208:209]
    v_mov_b64 v[34:35], v[208:209]
    v_mov_b64 v[36:37], v[208:209]
    v_mov_b64 v[38:39], v[208:209]
    v_mov_b64 v[40:41], v[208:209]
    v_mov_b64 v[42:43], v[208:209]
    v_mov_b64 v[44:45], v[208:209]
    v_mov_b64 v[46:47], v[208:209]
    s_mov_b64 exec, 0x000f000f
    v_mov_b32 v216, v48
    v_mov_b32 v217, v48
    v_mov_b32 v218, v48
    v_mov_b32 v219, v48
    s_mov_b64 exec, -1
    s_mov_b32 s60, 1
    s_waitcnt lgkmcnt(0)
    s_branch L_q_go
L_q_cs1:
    s_mov_b32 s60, 0
    v_mov_b64 v[208:209], v[224:225]
    v_mov_b64 v[210:211], v[226:227]
    v_mov_b64 v[212:213], v[228:229]
    v_mov_b64 v[214:215], v[230:231]
    v_mov_b64 v[216:217], v[232:233]
    v_mov_b64 v[218:219], v[234:235]
    v_mov_b64 v[32:33], v[112:113]
    v_mov_b64 v[34:35], v[114:115]
    v_mov_b64 v[36:37], v[116:117]
    v_mov_b64 v[38:39], v[118:119]
    v_mov_b64 v[40:41], v[120:121]
    v_mov_b64 v[42:43], v[122:123]
    v_mov_b64 v[44:45], v[124:125]
    v_mov_b64 v[46:47], v[126:127]
    v_mov_b64 v[160:161], 0
    v_mov_b64 v[162:163], 0
    v_mov_b64 v[164:165], 0
    v_mov_b64 v[166:167], 0
    v_mov_b64 v[168:169], 0
    v_mov_b64 v[170:171], 0
    v_mov_b64 v[172:173], 0
    v_mov_b64 v[174:175], 0
    v_mov_b64 v[176:177], 0
    v_mov_b64 v[178:179], 0
    s_nop 1
    v_smfmac_f32_16x16x64_bf16 v[176:179], v[212:215], v[100:107], v30
    s_branch L_q_go
L_o:
    s_getpc_b64 s[96:97]
L_pc:
    s_sub_u32 s96, s96, L_pc-L_kv
    s_subb_u32 s97, s97, 0
    v_lshrrev_b32 v5, 5, v0
    v_lshl_add_u32 v5, s33, 3, v5
    v_lshlrev_b32 v5, 7, v5
    v_min_u32 v5, L_text_end-L_kv+1020, v5
    global_load_dword v245, v5, s[96:97] offset:-1024
    v_and_b32 v1, 63, v0
    v_and_b32 v3, 15, v1
    v_lshrrev_b32 v4, 4, v1
    s_mov_b32 s22, 268435456
    s_mov_b32 s23, 0x20000
    s_mov_b32 s26, 256
    s_mov_b32 s27, 0x20000
    s_mov_b32 s7, 0x20000
    s_mov_b32 s11, 0x20000
    s_mov_b32 s37, 131072
    s_lshl_b32 s35, s32, 16
    s_mov_b32 s34, 0
    s_mov_b32 s36, 0
    s_mov_b32 s6, 4718592
    s_mov_b32 s10, 4718592
    s_mov_b32 s14, 2304
    s_mov_b32 s15, 0x20000
    s_mov_b32 s30, 2304
    s_mov_b32 s31, 0x20000
    s_and_b32 s100, s33, 7
    s_lshr_b32 s101, s33, 3
    s_mul_i32 s96, s32, 11
    s_lshr_b32 s96, s96, 5
    s_mul_i32 s96, s96, 8704
    s_mul_i32 s39, s32, 2560
    s_add_u32 s39, s39, s96
    v_lshrrev_b32 v5, 3, v1
    v_and_b32 v6, 7, v1
    v_lshrrev_b32 v7, 5, v1
    v_lshlrev_b32 v7, 1, v7
    v_xor_b32 v7, v7, v6
    v_lshlrev_b32 v24, 4, v7
    v_mul_u32_u24 v48, 1152, v5
    v_xor_b32 v25, 64, v24
    v_add_u32 v24, v24, v48
    v_add_u32 v25, v25, v48
    v_mul_u32_u24 v26, 1152, v1
    s_waitcnt lgkmcnt(0)
    s_cmp_eq_u32 s101, 0
    s_cselect_b64 s[4:5], s[56:57], s[42:43]
    s_cselect_b64 s[8:9], s[42:43], s[40:41]
    s_mov_b64 s[24:25], s[46:47]
    s_mov_b64 s[12:13], s[48:49]
    s_mov_b64 s[28:29], s[44:45]
    v_mov_b32 v36, -1
    v_mov_b32 v37, -1
    v_mov_b32 v38, -1
    v_mov_b32 v39, -1
    s_mul_i32 s96, s100, 224
    s_sub_u32 s96, 1792, s96
    v_lshlrev_b32 v40, 4, v1
    v_mul_u32_u24 v41, s96, v4
    v_add_u32 v41, v41, v40
    s_sub_u32 s58, s3, 4
    s_lshl_b32 s96, s32, 2
    s_add_u32 s96, s96, s58
    s_mul_i32 s61, s96, 147456
    s_mov_b32 s97, s58
    s_lshl_b32 s96, s100, 7
    s_add_u32 s96, s96, 12288
    v_mov_b32 v12, s96
    s_lshl_b32 s98, s97, 10
    s_add_u32 s98, s98, 110592
    v_and_b32 v48, 31, v1
    v_lshl_add_u32 v8, v48, 5, s98
    v_and_b32 v49, 16, v1
    v_add_u32 v8, v8, v49
    v_xor_b32 v204, 16, v8
    v_and_b32 v49, 7, v48
    v_lshlrev_b32 v49, 1, v49
    v_and_b32 v50, 16, v48
    v_add_u32 v49, v49, v50
    s_lshl_b32 s98, s100, 8
    s_lshl_b32 s99, s97, 6
    s_add_u32 s98, s98, s99
    s_lshl_b32 s99, s100, 5
    s_add_u32 s99, s99, 2048
    s_cmp_eq_u32 s97, 4
    s_cselect_b32 s98, s99, s98
    s_cselect_b32 s99, 0, 8
    s_cselect_b32 s96, 1, 3
    v_and_b32 v50, s99, v48
    v_lshl_add_u32 v49, v50, 2, v49
    s_add_u32 s98, s98, s39
    v_add_u32 v9, s98, v49
    v_lshrrev_b32 v50, 5, v1
    v_lshl_add_u32 v9, v50, 13, v9
    v_lshrrev_b32 v48, 2, v3
    v_and_b32 v48, s96, v48
    v_and_b32 v49, 1, v1
    v_bfe_u32 v50, v1, 1, 1
    v_and_b32 v51, 1, v4
    s_and_b32 s96, s33, 1
    s_mul_i32 s98, s96, 1152
    s_lshl_b32 s99, s97, 8
    s_add_u32 s98, s98, s99
    v_lshl_add_u32 v52, v48, 6, s98
    v_lshl_add_u32 v52, v49, 5, v52
    v_lshl_add_u32 v52, v50, 4, v52
    v_mul_u32_u24 v53, 2560, v4
    v_add_u32 v52, v52, v53
    v_lshrrev_b32 v53, 1, v4
    v_and_b32 v54, v53, v4
    v_mul_u32_u24 v53, 8704, v53
    v_mul_u32_u24 v54, 8704, v54
    v_add_u32 v10, v52, v54
    v_add_u32 v53, 18944, v53
    v_add_u32 v194, v52, v53
    s_lshr_b32 s98, s98, 1
    v_mul_u32_u24 v14, 1152, v50
    v_lshl_add_u32 v14, v48, 5, v14
    v_lshl_add_u32 v14, v49, 4, v14
    v_lshl_add_u32 v14, v51, 3, v14
    v_add_u32 v14, s98, v14
    s_mul_i32 s98, s97, 320
    s_add_u32 s98, s98, 116736
    v_and_b32 v52, 3, v1
    v_lshlrev_b32 v52, 4, v52
    v_lshl_add_u32 v11, v48, 6, v52
    v_lshl_add_u32 v11, v51, 3, v11
    v_add_u32 v11, s98, v11
    v_lshrrev_b32 v48, 2, v3
    v_mul_u32_u24 v48, 320, v48
    v_lshl_add_u32 v48, v4, 6, v48
    v_add_u32 v48, 116736, v48
    v_add_u32 v15, v48, v52
    v_lshlrev_b32 v49, 4, v49
    v_mov_b32 v53, 0x3f80
    v_lshlrev_b32 v53, v49, v53
    v_bfe_u32 v49, v1, 1, 2
    v_cmp_eq_u32 vcc, 0, v49
    s_nop 1
    v_cndmask_b32 v188, 0, v53, vcc
    v_cmp_eq_u32 vcc, 1, v49
    s_nop 1
    v_cndmask_b32 v189, 0, v53, vcc
    v_cmp_eq_u32 vcc, 2, v49
    s_nop 1
    v_cndmask_b32 v190, 0, v53, vcc
    v_cmp_eq_u32 vcc, 3, v49
    s_nop 1
    v_cndmask_b32 v191, 0, v53, vcc
    s_mov_b32 s38, 1048576
    v_mov_b32 v13, 14848
    v_mov_b64 v[224:225], 0
    v_mov_b64 v[226:227], 0
    v_mov_b64 v[228:229], 0
    v_mov_b64 v[230:231], 0
    v_mov_b64 v[232:233], 0
    v_mov_b64 v[234:235], 0
    v_mov_b32 v48, 118144
    ds_write_b128 v48, v[224:227]
    v_and_b32 v49, 3, v1
    v_lshlrev_b32 v49, 4, v49
    v_and_b32 v50, 12, v1
    v_add_u32 v49, v49, v50
    v_lshl_add_u32 v49, v4, 6, v49
    v_min_u32 v49, 128, v49
    v_add_u32 v47, 118016, v49
    s_lshr_b32 s96, s33, 1
    s_xor_b32 s96, s96, 4
    s_and_b32 s97, s96, 3
    s_xor_b32 s62, s58, 3
    s_lshr_b32 s62, s62, 1
    s_or_b32 s62, s97, s62
    s_mov_b32 s63, 0
    s_lshr_b32 s96, s96, 2
    s_lshl_b32 s96, s96, 5
    s_and_b32 s97, s33, 1
    s_lshl3_add_u32 s96, s97, s96
    s_add_u32 s96, s96, 14848
    v_and_b32 v49, 2, v1
    v_lshlrev_b32 v49, 3, v49
    s_and_b32 s97, s58, 1
    s_lshl2_add_u32 s96, s97, s96
    v_add_u32 v13, s96, v49
    v_bfe_u32 v48, v1, 2, 1
    v_bfe_u32 v49, v1, 3, 1
    v_and_b32 v50, 1, v4
    v_lshrrev_b32 v51, 1, v4
    v_lshl_add_u32 v56, v51, 4, v48
    v_lshl_add_u32 v56, v50, 2, v56
    v_lshl_add_u32 v56, v49, 3, v56
    v_lshl_add_u32 v57, v49, 1, v50
    s_lshl_b32 s96, s58, 14
    s_add_u32 s96, s96, 36864
    v_lshlrev_b32 v28, 7, v56
    v_lshl_add_u32 v28, v57, 5, v28
    v_and_b32 v48, 3, v1
    v_lshl_add_u32 v28, v48, 3, v28
    v_add_u32 v28, s96, v28
    v_xor_b32 v29, 32, v28
    v_xor_b32 v30, 64, v28
    v_xor_b32 v31, 96, v28
    s_lshl_b32 s96, s58, 11
    s_add_u32 s97, s96, 102400
    v_and_b32 v48, 1, v1
    v_lshlrev_b32 v27, 3, v48
    v_lshl_add_u32 v27, v56, 4, v27
    v_add_u32 v27, s97, v27
    s_add_u32 s96, s96, 4096
    v_lshlrev_b32 v32, 4, v1
    v_add_u32 v32, s96, v32
    s_lshl_b32 s96, s58, 8
    s_add_u32 s97, s96, 15360
    v_and_b32 v48, 31, v1
    v_lshlrev_b32 v33, 3, v48
    v_add_u32 v33, s97, v33
    v_lshrrev_b32 v49, 2, v48
    v_lshrrev_b32 v50, 5, v1
    v_add_u32 v49, v49, v50
    s_lshl_b32 s96, s58, 1
    v_add_u32 v49, s96, v49
    v_and_b32 v49, 7, v49
    v_lshlrev_b32 v49, 2, v49
    v_lshl_add_u32 v34, v48, 5, v49
    v_add_u32 v34, 110592, v34
    v_bfe_u32 v35, v1, 3, 1
    v_mul_u32_u24 v35, 0xaaaa, v35
    v_add_u32 v35, 0x4444, v35
    s_barrier
    s_cmp_eq_u32 s3, 4
    s_cbranch_scc0 L_skip_30
    s_lshl_b32 s96, s33, 12
    s_add_u32 s96, s96, s35
    buffer_store_dwordx4 v[36:39], v40, s[20:23], s96 offen offset:0 sc1
    buffer_store_dwordx4 v[36:39], v40, s[20:23], s96 offen offset:1024 sc1
    buffer_store_dwordx4 v[36:39], v40, s[20:23], s96 offen offset:2048 sc1
    buffer_store_dwordx4 v[36:39], v40, s[20:23], s96 offen offset:3072 sc1
    s_lshl_b32 s96, s100, 8
    s_mul_i32 s97, s101, 65536
    s_add_u32 s96, s96, s97
    s_add_u32 s96, s96, s39
    s_add_u32 s96, s96, 1048576
    s_add_u32 s97, s96, 131072
    s_mov_b64 exec, 0x3ffff
    buffer_store_dwordx4 v[36:39], v41, s[20:23], s96 offen sc1
    buffer_store_dwordx4 v[36:39], v41, s[20:23], s97 offen sc1
    s_add_u32 s96, s96, 8192
    s_add_u32 s97, s97, 8192
    buffer_store_dwordx4 v[36:39], v41, s[20:23], s96 offen sc1
    buffer_store_dwordx4 v[36:39], v41, s[20:23], s97 offen sc1
    s_mov_b64 exec, -1
    s_nop 0
L_skip_30:
    buffer_load_dwordx2 v[184:185], v14, s[12:15], 0 offen
    s_mov_b32 s59, 0
    s_lshl_b32 s56, s58, 14
    s_add_u32 s56, s56, 36864
    s_lshl_b32 s57, s100, 7
    s_add_u32 s57, s57, s61
    s_lshl_b32 s96, s32, 5
    s_lshl_b32 s97, s100, 2
    s_add_u32 s96, s96, s97
    s_add_u32 s96, s96, s58
    s_mul_i32 s96, s96, 18432
    s_lshl_b32 s98, s58, 11
    s_add_u32 m0, s98, 102400
    s_add_u32 s99, s96, 1024
    buffer_load_dwordx4 v24, s[4:7], s99 offen lds
    s_add_u32 m0, s98, 103424
    s_add_u32 s99, s96, 10240
    buffer_load_dwordx4 v24, s[4:7], s99 offen lds
    s_cmp_eq_u32 s101, 0
    s_cselect_b32 s96, 10, 0
L_wo_31:
    s_cmp_ge_u32 s59, s96
    s_cbranch_scc1 L_wod_32
    s_mov_b32 m0, s56
    s_add_u32 s56, s56, 1024
    buffer_load_dwordx4 v24, s[4:7], s57 offen nt lds
    s_add_u32 s57, s57, 9216
    s_mov_b32 m0, s56
    s_add_u32 s56, s56, 1024
    buffer_load_dwordx4 v25, s[4:7], s57 offen nt lds
    s_add_u32 s57, s57, 9216
    s_add_u32 s59, s59, 2
    s_branch L_wo_31
L_wod_32:
    s_cmp_eq_u32 s101, 1
    s_cbranch_scc0 L_skip_33
    s_nop 0
    s_cmp_ge_u32 s100, 6
    s_cbranch_scc1 L_nt_34
    s_lshl2_add_u32 s96, s100, s58
    s_lshr_b32 s97, s96, 1
    s_mul_i32 s97, s97, 48
    s_and_b32 s96, s96, 1
    s_mul_i32 s98, s96, s32
    s_mul_i32 s99, s96, 7
    s_cmp_eq_u32 s98, s99
    s_cbranch_scc0 L_nt_34
    s_lshl2_add_u32 s96, s96, 3
    s_lshl3_add_u32 s96, s32, s96
    s_lshl_b32 s96, s96, 7
    v_min_u32 v48, 47, v1
    v_add_u32 v48, s97, v48
    v_lshlrev_b32 v48, 13, v48
    buffer_load_dword v244, v48, s[8:11], s96 offen
L_nt_34:
    s_nop 0
L_skip_33:
    s_barrier
    s_cmp_eq_u32 s101, 0
    s_cbranch_scc1 L_wa_35
    s_waitcnt vmcnt(2)
    s_branch L_wb_36
L_wa_35:
    s_waitcnt vmcnt(12)
L_wb_36:
    v_lshlrev_b32 v180, 16, v184
    v_and_b32 v181, 0xffff0000, v184
    v_lshlrev_b32 v182, 16, v185
    v_and_b32 v183, 0xffff0000, v185
    s_mov_b32 s60, 0
    s_cmp_eq_u32 s3, 4
    s_cbranch_scc0 L_skip_37
    s_getreg_b32 s96, hwreg(HW_REG_XCC_ID, 0, 4)
    s_lshr_b32 s97, s33, 4
    s_lshl_b32 s97, s97, 10
    s_and_b32 s98, s33, 15
    s_lshl_b32 s98, s98, 2
    s_add_u32 s97, s97, s98
    s_lshl_b32 s98, s32, 7
    s_add_u32 s97, s97, s98
    s_add_u32 s97, s97, 1110016
    v_mov_b32 v48, s96
    v_mov_b32 v49, 0
    s_mov_b64 exec, 1
    buffer_store_dword v48, v49, s[20:23], s97 offen
    buffer_store_dword v48, v49, s[20:23], s97 offen offset:2048 sc1
    s_mov_b64 exec, -1
L_skip_37:
    s_barrier
    s_setprio 1
    s_lshl_b32 s98, s58, 11
    s_lshl_b32 s97, s100, 4
    s_add_u32 s97, s97, s61
    s_add_u32 m0, s98, 102400
    s_add_u32 s99, s97, 1024
    buffer_load_dwordx4 v26, s[4:7], s99 offen lds
    s_add_u32 m0, s98, 103424
    s_add_u32 s99, s97, 74752
    buffer_load_dwordx4 v26, s[4:7], s99 offen lds
    s_cmp_eq_u32 s101, 1
    s_cbranch_scc0 L_skip_38
L_wo_39:
    s_cmp_ge_u32 s59, 6
    s_cbranch_scc1 L_wod_40
    s_mov_b32 m0, s56
    s_add_u32 s56, s56, 1024
    buffer_load_dwordx4 v24, s[4:7], s57 offen nt lds
    s_add_u32 s57, s57, 9216
    s_mov_b32 m0, s56
    s_add_u32 s56, s56, 1024
    buffer_load_dwordx4 v25, s[4:7], s57 offen nt lds
    s_add_u32 s57, s57, 9216
    s_add_u32 s59, s59, 2
    s_branch L_wo_39
L_wod_40:
    s_setprio 0
    s_barrier
    v_and_b32 v56, 1, v4
    v_lshlrev_b32 v56, 10, v56
    v_lshl_add_u32 v56, v3, 2, v56
    s_lshl_b32 s96, s32, 7
    s_add_u32 s96, s96, 1110016
    s_add_u32 s97, s96, 2048
    s_mov_b32 s99, 64
L_poll_41:
    buffer_load_dword v57, v56, s[20:23], s96 offen sc1
    s_sub_u32 s37, s37, 1
    s_cmp_lt_i32 s37, 0
    s_cbranch_scc1 L_pdone_42
    s_sub_u32 s99, s99, 1
    s_cselect_b32 s96, s97, s96
    s_sleep 8
    s_waitcnt vmcnt(0)
    v_cmp_eq_u32 vcc, -1, v57
    s_cbranch_vccnz L_poll_41
L_pdone_42:
    s_getreg_b32 s96, hwreg(HW_REG_XCC_ID, 0, 4)
    v_cmp_ne_u32 vcc, s96, v57
    s_nop 1
    s_cmp_eq_u64 vcc, 0
    s_cselect_b32 s36, 1, 0
    s_branch L_fl
L_skip_38:
L_o_first:
L_wo_43:
    s_cmp_ge_u32 s59, 16
    s_cbranch_scc1 L_wod_44
    s_mov_b32 m0, s56
    s_add_u32 s56, s56, 1024
    buffer_load_dwordx4 v24, s[4:7], s57 offen nt lds
    s_add_u32 s57, s57, 9216
    s_mov_b32 m0, s56
    s_add_u32 s56, s56, 1024
    buffer_load_dwordx4 v25, s[4:7], s57 offen nt lds
    s_add_u32 s57, s57, 9216
    s_add_u32 s59, s59, 2
    s_branch L_wo_43
L_wod_44:
    s_setprio 0
    v_and_b32 v56, 1, v4
    v_lshlrev_b32 v56, 10, v56
    v_lshl_add_u32 v56, v3, 2, v56
    s_lshl_b32 s96, s32, 7
    s_add_u32 s96, s96, 1110016
    s_add_u32 s97, s96, 2048
    s_mov_b32 s99, 64
L_poll_45:
    buffer_load_dword v57, v56, s[20:23], s96 offen sc1
    s_sub_u32 s37, s37, 1
    s_cmp_lt_i32 s37, 0
    s_cbranch_scc1 L_pdone_46
    s_sub_u32 s99, s99, 1
    s_cselect_b32 s96, s97, s96
    s_sleep 8
    s_waitcnt vmcnt(0)
    v_cmp_eq_u32 vcc, -1, v57
    s_cbranch_vccnz L_poll_45
L_pdone_46:
    s_getreg_b32 s96, hwreg(HW_REG_XCC_ID, 0, 4)
    v_cmp_ne_u32 vcc, s96, v57
    s_nop 1
    s_cmp_eq_u64 vcc, 0
    s_cselect_b32 s36, 1, 0
    ds_read_b64_tr_b16 v[64:65], v28 offset:0
    ds_read_b64_tr_b16 v[66:67], v28 offset:256
    ds_read_b64_tr_b16 v[68:69], v28 offset:4096
    ds_read_b64_tr_b16 v[70:71], v28 offset:4352
    ds_read_b64_tr_b16 v[72:73], v28 offset:8192
    ds_read_b64_tr_b16 v[74:75], v28 offset:8448
    ds_read_b64_tr_b16 v[76:77], v28 offset:12288
    ds_read_b64_tr_b16 v[78:79], v28 offset:12544
    ds_read_b64_tr_b16 v[80:81], v29 offset:0
    ds_read_b64_tr_b16 v[82:83], v29 offset:256
    ds_read_b64_tr_b16 v[84:85], v29 offset:4096
    ds_read_b64_tr_b16 v[86:87], v29 offset:4352
    ds_read_b64_tr_b16 v[88:89], v29 offset:8192
    ds_read_b64_tr_b16 v[90:91], v29 offset:8448
    ds_read_b64_tr_b16 v[92:93], v29 offset:12288
    ds_read_b64_tr_b16 v[94:95], v29 offset:12544
    ds_read_b64_tr_b16 v[96:97], v30 offset:0
    ds_read_b64_tr_b16 v[98:99], v30 offset:256
    ds_read_b64_tr_b16 v[100:101], v30 offset:4096
    ds_read_b64_tr_b16 v[102:103], v30 offset:4352
    ds_read_b64_tr_b16 v[104:105], v30 offset:8192
    ds_read_b64_tr_b16 v[106:107], v30 offset:8448
    ds_read_b64_tr_b16 v[108:109], v30 offset:12288
    ds_read_b64_tr_b16 v[110:111], v30 offset:12544
    ds_read_b64_tr_b16 v[112:113], v31 offset:0
    ds_read_b64_tr_b16 v[114:115], v31 offset:256
    ds_read_b64_tr_b16 v[116:117], v31 offset:4096
    ds_read_b64_tr_b16 v[118:119], v31 offset:4352
    ds_read_b64_tr_b16 v[120:121], v31 offset:8192
    ds_read_b64_tr_b16 v[122:123], v31 offset:8448
    ds_read_b64_tr_b16 v[124:125], v31 offset:12288
    ds_read_b64_tr_b16 v[126:127], v31 offset:12544
    ds_read_b64_tr_b16 v[128:129], v27 offset:0
    ds_read_b64_tr_b16 v[130:131], v27 offset:32
    ds_read_b64_tr_b16 v[132:133], v27 offset:512
    ds_read_b64_tr_b16 v[134:135], v27 offset:544
    ds_read_b64_tr_b16 v[136:137], v27 offset:1024
    ds_read_b64_tr_b16 v[138:139], v27 offset:1056
    ds_read_b64_tr_b16 v[140:141], v27 offset:1536
    ds_read_b64_tr_b16 v[142:143], v27 offset:1568
    s_waitcnt lgkmcnt(0)
    s_branch L_o_go
L_stats:
    ds_read_b32 v212, v47
    s_setprio 3
    v_mov_b32 v50, 0
    s_bitcmp1_b32 s58, 0
    s_cbranch_scc0 L_st1
    s_waitcnt lgkmcnt(1)
    v_dot2c_f32_bf16 v50, v208, v208
    v_dot2c_f32_bf16 v50, v209, v209
    v_dot2c_f32_bf16 v50, v210, v210
    v_dot2c_f32_bf16 v50, v211, v211
    s_waitcnt lgkmcnt(0)
    v_dot2c_f32_bf16 v50, v212, v212
L_st2:
    s_nop 2
    v_add_f32_dpp v50, v50, v50 quad_perm:[1,0,3,2] row_mask:0xf bank_mask:0xf
    s_nop 1
    v_add_f32_dpp v50, v50, v50 row_ror:4 row_mask:0xf bank_mask:0xf
    s_cmp_eq_u32 s36, 0
    s_nop 0
    v_add_f32_dpp v51, v50, v50 row_ror:8 row_mask:0xf bank_mask:0xf
    v_add_f32_dpp v50, v50, v50 row_ror:8 row_mask:0xf bank_mask:0xf
    s_nop 1
    v_permlane32_swap_b32 v50, v51
    v_add_f32 v52, v50, v51
    v_add_f32 v50, v50, v51
    s_cbranch_scc1 L_sg_47
    s_nop 0
    v_permlane16_swap_b32 v50, v52
    v_add_f32 v50, v50, v52
    buffer_store_dword v50, v13, s[20:23], s35 offen
L_se_48:
    s_setprio 0
L_o_loop:
    v_mov_b64 v[180:181], v[184:185]
    v_mov_b64 v[182:183], v[186:187]
    s_lshl1_add_u32 s96, s34, s101
    s_cmp_eq_u32 s96, 3
    s_cbranch_scc0 L_o_go
    s_sleep 4
    s_branch L_o_first
L_o_go:
    s_and_b32 s96, s34, 1
    s_cmp_eq_u32 s96, s101
    s_cbranch_scc0 L_fl
    s_cmp_ge_u32 s34, 2
    s_cbranch_scc0 L_skip_50
    s_sleep 12
L_skip_50:
L_o_again:
    v_mov_b64 v[168:169], 0
    v_mov_b64 v[170:171], 0
    v_mov_b64 v[172:173], 0
    v_mov_b64 v[174:175], 0
    v_mov_b64 v[176:177], 0
    v_mov_b64 v[178:179], 0
L_o_top:
    buffer_load_dwordx2 v[44:45], v33, s[20:23], s35 offen sc1
    buffer_load_dwordx4 v[36:39], v32, s[20:23], s35 offen sc1
    buffer_load_dwordx4 v[40:43], v32, s[20:23], s35 offen offset:1024 sc1
    s_sub_u32 s37, s37, 1
    s_cmp_lt_i32 s37, 0
    s_cbranch_scc1 L_o_on
    v_mov_b64 v[160:161], 0
    v_mov_b64 v[162:163], 0
    v_mov_b64 v[164:165], 0
    v_mov_b64 v[166:167], 0
    s_nop 0
    s_waitcnt vmcnt(1)
    v_smfmac_f32_16x16x64_bf16 v[160:163], v[36:39], v[64:71], v35
    v_max_f32_dpp v54, v44, v44 row_ror:4 row_mask:0xf bank_mask:0xf
    v_add_f32_dpp v55, v45, v45 quad_perm:[1,0,3,2] row_mask:0xf bank_mask:0xf
    s_waitcnt vmcnt(0)
    v_smfmac_f32_16x16x64_bf16 v[160:163], v[40:43], v[72:79], v35
    v_max3_u32 v48, v45, v39, v43
    v_cmp_eq_u32 vcc, -1, v48
    v_smfmac_f32_16x16x64_bf16 v[164:167], v[36:39], v[80:87], v35
    v_max_f32_dpp v54, v54, v54 row_ror:8 row_mask:0xf bank_mask:0xf
    s_cbranch_vccnz L_o_top
L_o_on:
    v_smfmac_f32_16x16x64_bf16 v[164:167], v[40:43], v[88:95], v35
    v_sub_f32 v53, v44, v54
    v_add_f32_dpp v55, v55, v55 quad_perm:[2,3,0,1] row_mask:0xf bank_mask:0xf
    v_smfmac_f32_16x16x64_bf16 v[168:171], v[36:39], v[96:103], v35
    v_exp_f32 v53, v53
    v_smfmac_f32_16x16x64_bf16 v[168:171], v[40:43], v[104:111], v35
    v_mul_f32 v55, v55, v53
    v_smfmac_f32_16x16x64_bf16 v[172:175], v[36:39], v[112:119], v35
    s_nop 0
    v_add_f32_dpp v55, v55, v55 row_ror:4 row_mask:0xf bank_mask:0xf
    v_smfmac_f32_16x16x64_bf16 v[172:175], v[40:43], v[120:127], v35
    s_nop 0
    v_add_f32_dpp v55, v55, v55 row_ror:8 row_mask:0xf bank_mask:0xf
    v_smfmac_f32_16x16x64_bf16 v[176:179], v[36:39], v[128:135], v35
    v_rcp_f32 v55, v55
    v_smfmac_f32_16x16x64_bf16 v[176:179], v[40:43], v[136:143], v35
    s_nop 0
    v_mul_f32_dpp v56, v53, v55 row_newbcast:0 row_mask:0xf bank_mask:0xf
    v_mul_f32_dpp v57, v53, v55 row_newbcast:4 row_mask:0xf bank_mask:0xf
    v_mul_f32_dpp v58, v53, v55 row_newbcast:8 row_mask:0xf bank_mask:0xf
    v_mul_f32_dpp v59, v53, v55 row_newbcast:12 row_mask:0xf bank_mask:0xf
    v_pk_mul_f32 v[224:225], v[160:161], v[56:57]
    v_pk_fma_f32 v[224:225], v[162:163], v[58:59], v[224:225]
    v_add_f32 v224, v224, v225
    ds_write_b32 v34, v224 offset:0
    v_pk_mul_f32 v[226:227], v[164:165], v[56:57]
    v_pk_fma_f32 v[226:227], v[166:167], v[58:59], v[226:227]
    v_add_f32 v226, v226, v227
    v_pk_mul_f32 v[228:229], v[168:169], v[56:57]
    v_pk_fma_f32 v[228:229], v[170:171], v[58:59], v[228:229]
    v_add_f32 v228, v228, v229
    ds_write2st64_b32 v34, v226, v228 offset0:4 offset1:8
    v_pk_mul_f32 v[230:231], v[172:173], v[56:57]
    v_pk_fma_f32 v[230:231], v[174:175], v[58:59], v[230:231]
    v_add_f32 v230, v230, v231
    v_pk_mul_f32 v[232:233], v[176:177], v[56:57]
    v_pk_fma_f32 v[232:233], v[178:179], v[58:59], v[232:233]
    v_add_f32 v232, v232, v233
    ds_write2st64_b32 v34, v230, v232 offset0:12 offset1:16
    v_cmp_u_f32 vcc, v224, v224
    s_cbranch_vccnz L_rt_51
L_rc_52:
    s_waitcnt lgkmcnt(0)
L_rg:
    s_barrier
    ds_read_b128 v[16:19], v8
    ds_read_b128 v[20:23], v204
    s_waitcnt lgkmcnt(1)
    v_pk_add_f32 v[16:17], v[16:17], v[18:19]
    s_waitcnt lgkmcnt(0)
    v_pk_add_f32 v[20:21], v[20:21], v[22:23]
    v_pk_add_f32 v[16:17], v[16:17], v[20:21]
    v_add_f32 v48, v16, v17
    v_cvt_pk_bf16_f32 v48, v48, v48
    buffer_store_short v48, v9, s[20:23], s38 offen sc1
    s_cmp_eq_u32 s34, 3
    s_cbranch_scc0 L_last_53
    s_cmp_eq_u32 s32, s100
    s_cbranch_scc0 L_w_next
    s_cmp_lt_u32 s32, 2
    s_cbranch_scc0 L_w_next
    s_sleep 5
    buffer_load_dwordx4 v[196:199], v10, s[20:23], s38 offen sc1
    buffer_load_dwordx4 v[200:203], v194, s[20:23], s38 offen sc1
    s_sleep 4
    buffer_load_dwordx4 v[236:239], v10, s[20:23], s38 offen sc1
    buffer_load_dwordx4 v[240:243], v194, s[20:23], s38 offen sc1
    s_sleep 4
L_gl:
    buffer_load_dwordx4 v[246:249], v10, s[20:23], s38 offen sc1
    buffer_load_dwordx4 v[250:253], v194, s[20:23], s38 offen sc1
    s_sub_u32 s37, s37, 1
    s_cmp_lt_i32 s37, 0
    s_cbranch_scc1 L_gl1
    s_waitcnt vmcnt(5)
    v_mfma_f32_16x16x32_bf16 v[184:187], v[188:191], v[196:199], v[180:183]
    s_waitcnt vmcnt(4)
    v_mfma_f32_16x16x32_bf16 v[184:187], v[188:191], v[200:203], v[184:187]
    s_nop 7
    v_cmp_u_f32 vcc, v184, v184
    v_cvt_pk_bf16_f32 v48, v184, v185
    v_cvt_pk_bf16_f32 v49, v186, v187
    s_cbranch_vccz L_gl1
    buffer_load_dwordx4 v[196:199], v10, s[20:23], s38 offen sc1
    buffer_load_dwordx4 v[200:203], v194, s[20:23], s38 offen sc1
    s_waitcnt vmcnt(5)
    v_mfma_f32_16x16x32_bf16 v[184:187], v[188:191], v[236:239], v[180:183]
    s_waitcnt vmcnt(4)
    v_mfma_f32_16x16x32_bf16 v[184:187], v[188:191], v[240:243], v[184:187]
    s_nop 7
    v_cmp_u_f32 vcc, v184, v184
    v_cvt_pk_bf16_f32 v48, v184, v185
    v_cvt_pk_bf16_f32 v49, v186, v187
    s_cbranch_vccz L_gl1
    buffer_load_dwordx4 v[236:239], v10, s[20:23], s38 offen sc1
    buffer_load_dwordx4 v[240:243], v194, s[20:23], s38 offen sc1
    s_waitcnt vmcnt(5)
    v_mfma_f32_16x16x32_bf16 v[184:187], v[188:191], v[246:249], v[180:183]
    s_waitcnt vmcnt(4)
    v_mfma_f32_16x16x32_bf16 v[184:187], v[188:191], v[250:253], v[184:187]
    s_nop 7
    v_cmp_u_f32 vcc, v184, v184
    v_cvt_pk_bf16_f32 v48, v184, v185
    v_cvt_pk_bf16_f32 v49, v186, v187
    s_cbranch_vccnz L_gl
L_gl1:
    buffer_store_dwordx2 v[48:49], v14, s[28:31], 0 offen
    s_endpgm
L_last_53:
    s_or_b32 s96, s34, s3
    s_cbranch_scc0 L_cs2
    s_sleep 7
    s_branch L_rg2
L_fl:
    s_cmp_eq_u32 s34, 3
    s_cbranch_scc1 L_w_next
    s_cmp_eq_u32 s34, 2
    s_cbranch_scc0 L_skip_54
    s_sleep 28
L_skip_54:
L_poll_55:
    buffer_load_dword v16, v12, s[20:23], s35 offen sc1
    s_sub_u32 s37, s37, 1
    s_cmp_lt_i32 s37, 0
    s_cbranch_scc1 L_pdone_56
    s_waitcnt vmcnt(0)
    v_cmp_eq_u32 vcc, -1, v16
    s_cbranch_vccnz L_poll_55
L_pdone_56:
    s_sleep 5
L_rg2:
    s_cmp_eq_u32 s34, 0
    s_cbranch_scc0 L_skip_57
    v_mov_b32 v48, 118160
    ds_read_b32 v48, v48
    s_waitcnt lgkmcnt(0)
    v_and_b32 v48, 8192, v48
    v_add_u32 v10, v10, v48
    v_add_u32 v194, v194, v48
    s_nop 1
L_skip_57:
    s_mov_b32 s39, s38
    s_add_u32 s38, s38, 65536
    s_add_u32 s34, s34, 1
    s_add_u32 s35, s35, 16384
    s_mov_b32 s55, s35
    v_mov_b64 v[160:161], 0
    v_mov_b64 v[162:163], 0
    v_mov_b64 v[164:165], 0
    v_mov_b64 v[166:167], 0
    v_mov_b64 v[168:169], 0
    v_mov_b64 v[170:171], 0
    v_mov_b64 v[172:173], 0
    v_mov_b64 v[174:175], 0
    v_mov_b64 v[176:177], 0
    v_mov_b64 v[178:179], 0
    buffer_load_dwordx4 v[196:199], v10, s[20:23], s39 offen sc1
    buffer_load_dwordx4 v[200:203], v194, s[20:23], s39 offen sc1
    s_sleep 5
L_g0:
    buffer_load_dwordx4 v[236:239], v10, s[20:23], s39 offen sc1
    buffer_load_dwordx4 v[240:243], v194, s[20:23], s39 offen sc1
    s_sub_u32 s37, s37, 1
    s_cmp_lt_i32 s37, 0
    s_cbranch_scc1 L_g1
    s_waitcnt vmcnt(3)
    v_mfma_f32_16x16x32_bf16 v[184:187], v[188:191], v[196:199], v[180:183]
    s_waitcnt vmcnt(2)
    v_mfma_f32_16x16x32_bf16 v[184:187], v[188:191], v[200:203], v[184:187]
    s_nop 7
    v_cvt_pk_bf16_f32 v48, v184, v185
    v_cvt_pk_bf16_f32 v49, v186, v187
    ds_write_b64 v11, v[48:49]
    v_cmp_u_f32 vcc, v184, v184
    s_cbranch_vccz L_g1
    buffer_load_dwordx4 v[196:199], v10, s[20:23], s39 offen sc1
    buffer_load_dwordx4 v[200:203], v194, s[20:23], s39 offen sc1
    s_waitcnt vmcnt(3)
    v_mfma_f32_16x16x32_bf16 v[184:187], v[188:191], v[236:239], v[180:183]
    s_waitcnt vmcnt(2)
    v_mfma_f32_16x16x32_bf16 v[184:187], v[188:191], v[240:243], v[184:187]
    s_nop 7
    v_cvt_pk_bf16_f32 v48, v184, v185
    v_cvt_pk_bf16_f32 v49, v186, v187
    ds_write_b64 v11, v[48:49]
    v_cmp_u_f32 vcc, v184, v184
    s_cbranch_vccnz L_g0
L_g1:
L_bx:
    s_cmp_lt_u32 s3, 4
    s_mov_b64 vcc, s[62:63]
    s_waitcnt lgkmcnt(0)
    s_barrier
    s_cbranch_vccnz L_o_loop
    ds_read_b128 v[208:211], v15
    s_cbranch_scc0 L_stats
    ds_read_b128 v[216:219], v28
    ds_read_b128 v[32:35], v31 offset:0
    ds_read_b128 v[36:39], v31 offset:320
    ds_read_b128 v[40:43], v31 offset:640
    ds_read_b128 v[44:47], v31 offset:960
    s_waitcnt lgkmcnt(5)
L_q_go:
    v_smfmac_f32_16x16x64_bf16 v[176:179], v[208:211], v[100:107], v30
    s_waitcnt lgkmcnt(4)
    v_smfmac_f32_16x16x64_bf16 v[176:179], v[216:219], v[96:103], v30
    s_waitcnt lgkmcnt(3)
    v_smfmac_f32_16x16x64_bf16 v[160:163], v[32:35], v[64:71], v30
    s_cmp_gt_u32 s36, s60
    s_waitcnt lgkmcnt(2)
    v_smfmac_f32_16x16x64_bf16 v[160:163], v[36:39], v[72:79], v30
    s_nop 0
    v_add_f32 v48, v176, v177
    s_waitcnt lgkmcnt(1)
    v_smfmac_f32_16x16x64_bf16 v[160:163], v[40:43], v[80:87], v30
    v_add_f32 v49, v178, v179
    s_waitcnt lgkmcnt(0)
    v_smfmac_f32_16x16x64_bf16 v[160:163], v[44:47], v[88:95], v30
    s_nop 0
    v_permlane32_swap_b32 v48, v49
    v_add_f32 v52, v48, v49
    v_add_f32 v48, v48, v49
    s_cbranch_scc0 L_q_cs
    s_nop 0
    v_permlane16_swap_b32 v48, v52
    v_add_f32 v48, v48, v52
    v_add_f32 v50, v160, v161
    v_add_f32 v50, v50, v48
    v_cvt_pk_bf16_f32 v50, v50, v50
    buffer_store_short v50, v29, s[20:23], s55 offen
L_q_st:
    s_cmp_eq_u32 s34, 0
    s_cbranch_scc0 L_q_swap
    s_barrier
    s_lshl_b32 s96, s32, 12
    s_add_u32 s96, s96, 1015808
    s_mov_b32 exec_lo, 0xffff
    s_mov_b32 exec_hi, 0xffff
    buffer_store_short v50, v29, s[20:23], s96 offen sc1
    s_mov_b64 exec, -1
    v_mov_b64 v[112:113], v[64:65]
    v_mov_b64 v[114:115], v[66:67]
    v_mov_b64 v[116:117], v[68:69]
    v_mov_b64 v[118:119], v[70:71]
    v_mov_b64 v[120:121], v[72:73]
    v_mov_b64 v[122:123], v[74:75]
    v_mov_b64 v[124:125], v[76:77]
    v_mov_b64 v[126:127], v[78:79]
    v_mov_b64 v[128:129], v[80:81]
    v_mov_b64 v[130:131], v[82:83]
    v_mov_b64 v[132:133], v[84:85]
    v_mov_b64 v[134:135], v[86:87]
    v_mov_b64 v[136:137], v[88:89]
    v_mov_b64 v[138:139], v[90:91]
    v_mov_b64 v[140:141], v[92:93]
    v_mov_b64 v[142:143], v[94:95]
    v_mov_b64 v[144:145], v[96:97]
    v_mov_b64 v[146:147], v[98:99]
    v_mov_b64 v[148:149], v[100:101]
    v_mov_b64 v[150:151], v[102:103]
    v_mov_b64 v[152:153], v[104:105]
    v_mov_b64 v[154:155], v[106:107]
    s_lshl_b32 s98, s3, 10
    s_add_u32 m0, s98, 0
    s_add_u32 s99, s61, 0
    buffer_load_dwordx4 v24, s[8:11], s99 offen nt lds
    s_add_u32 m0, s98, 4096
    s_add_u32 s99, s61, 262144
    buffer_load_dwordx4 v24, s[8:11], s99 offen nt lds
    s_add_u32 m0, s98, 8192
    s_add_u32 s99, s61, 524288
    buffer_load_dwordx4 v24, s[8:11], s99 offen nt lds
    s_add_u32 m0, s98, 12288
    s_add_u32 s99, s61, 786432
    buffer_load_dwordx4 v24, s[8:11], s99 offen nt lds
    s_add_u32 m0, s98, 16384
    s_add_u32 s99, s61, 1048576
    buffer_load_dwordx4 v24, s[8:11], s99 offen nt lds
    s_add_u32 m0, s98, 20480
    s_add_u32 s99, s61, 1310720
    buffer_load_dwordx4 v24, s[8:11], s99 offen nt lds
    s_add_u32 m0, s98, 24576
    s_add_u32 s99, s61, 1572864
    buffer_load_dwordx4 v24, s[8:11], s99 offen nt lds
    s_add_u32 m0, s98, 28672
    s_add_u32 s99, s61, 1835008
    buffer_load_dwordx4 v24, s[8:11], s99 offen nt lds
    s_add_u32 m0, s98, 32768
    s_add_u32 s99, s61, 2097152
    buffer_load_dwordx4 v24, s[8:11], s99 offen nt lds
    v_lshlrev_b32 v180, 16, v184
    v_and_b32 v181, 0xffff0000, v184
    v_lshlrev_b32 v182, 16, v185
    v_and_b32 v183, 0xffff0000, v185
    s_cmp_eq_u32 s3, 1
    s_cbranch_scc0 L_skip_58
    s_lshl_b32 s96, s33, 7
    s_add_u32 s96, s96, 1097728
    s_add_u32 s16, s20, s96
    s_addc_u32 s17, s21, 0
    s_memtime s[40:41]
    s_load_dword s97, s[16:17], 0x0
    s_waitcnt lgkmcnt(0)
    s_memtime s[42:43]
    s_load_dword s97, s[16:17], 0x2000
    s_waitcnt lgkmcnt(0)
    s_memtime s[44:45]
    s_load_dword s97, s[16:17], 0x800
    s_waitcnt lgkmcnt(0)
    s_memtime s[46:47]
    s_load_dword s97, s[16:17], 0x2800
    s_waitcnt lgkmcnt(0)
    s_memtime s[48:49]
    s_waitcnt lgkmcnt(0)
    s_sub_u32 s40, s42, s40
    s_sub_u32 s42, s44, s42
    s_sub_u32 s44, s46, s44
    s_sub_u32 s46, s48, s46
    s_min_u32 s40, s40, s44
    s_min_u32 s42, s42, s46
    s_cmp_lt_u32 s42, s40
    s_cselect_b32 s96, 8192, 0
    v_mov_b32 v48, 118160
    v_mov_b32 v49, s96
    ds_write_b32 v48, v49
    s_waitcnt lgkmcnt(0)
L_skip_58:
    v_and_b32 v56, 1, v4
    v_lshlrev_b32 v56, 10, v56
    v_lshl_add_u32 v56, v3, 2, v56
    s_lshl_b32 s96, s32, 7
    s_add_u32 s96, s96, 1110016
    s_add_u32 s97, s96, 2048
    s_mov_b32 s99, 64
L_poll_59:
    buffer_load_dword v57, v56, s[20:23], s96 offen sc1
    s_sub_u32 s37, s37, 1
    s_cmp_lt_i32 s37, 0
    s_cbranch_scc1 L_pdone_60
    s_sub_u32 s99, s99, 1
    s_cselect_b32 s96, s97, s96
    s_sleep 8
    s_waitcnt vmcnt(0)
    v_cmp_eq_u32 vcc, -1, v57
    s_cbranch_vccnz L_poll_59
L_pdone_60:
    s_getreg_b32 s96, hwreg(HW_REG_XCC_ID, 0, 4)
    v_cmp_ne_u32 vcc, s96, v57
    s_nop 1
    s_cmp_eq_u64 vcc, 0
    s_cselect_b32 s36, 1, 0
    s_or_b32 s96, s3, s101
    s_cbranch_scc0 L_rg
    s_barrier
    s_lshl2_add_u32 s96, s101, s3
    s_cmp_eq_u32 s96, 1
    s_cbranch_scc0 L_skip_61
    s_cmp_eq_u32 s36, 0
    s_mov_b64 exec, 1
    s_cbranch_scc1 L_sg_62
    buffer_store_dword v12, v12, s[20:23], s35 offen
L_se_63:
    s_mov_b64 exec, -1
L_skip_61:
L_cs2:
    ds_read_b64_tr_b16 v[64:65], v25 offset:0
    ds_read_b64_tr_b16 v[66:67], v25 offset:256
    ds_read_b64_tr_b16 v[68:69], v25 offset:4096
    ds_read_b64_tr_b16 v[70:71], v25 offset:4352
    ds_read_b64_tr_b16 v[72:73], v25 offset:8192
    ds_read_b64_tr_b16 v[74:75], v25 offset:8448
    ds_read_b64_tr_b16 v[76:77], v25 offset:12288
    ds_read_b64_tr_b16 v[78:79], v25 offset:12544
    ds_read_b64_tr_b16 v[80:81], v25 offset:16384
    ds_read_b64_tr_b16 v[82:83], v25 offset:16640
    ds_read_b64_tr_b16 v[84:85], v25 offset:20480
    ds_read_b64_tr_b16 v[86:87], v25 offset:20736
    ds_read_b64_tr_b16 v[88:89], v25 offset:24576
    ds_read_b64_tr_b16 v[90:91], v25 offset:24832
    ds_read_b64_tr_b16 v[92:93], v25 offset:28672
    ds_read_b64_tr_b16 v[94:95], v25 offset:28928
    ds_read_b64_tr_b16 v[96:97], v25 offset:32768
    ds_read_b64_tr_b16 v[98:99], v25 offset:33024
    v_mov_b64 v[100:101], 0
    v_mov_b64 v[102:103], 0
    v_mov_b64 v[104:105], 0
    v_mov_b64 v[106:107], 0
    v_mov_b64 v[160:161], 0
    v_mov_b64 v[162:163], 0
    v_mov_b64 v[164:165], 0
    v_mov_b64 v[166:167], 0
    v_mov_b64 v[168:169], 0
    v_mov_b64 v[170:171], 0
    v_mov_b64 v[172:173], 0
    v_mov_b64 v[174:175], 0
    v_mov_b64 v[176:177], 0
    v_mov_b64 v[178:179], 0
    v_mov_b64 v[216:217], 0
    v_mov_b64 v[218:219], 0
    v_mov_b32 v48, 0x3f803f80
    v_mov_b32 v208, v48
    v_mov_b32 v209, v48
    v_mov_b32 v210, v48
    v_mov_b32 v211, v48
    v_mov_b64 v[32:33], v[208:209]
    v_mov_b64 v[34:35], v[208:209]
    v_mov_b64 v[36:37], v[208:209]
    v_mov_b64 v[38:39], v[208:209]
    v_mov_b64 v[40:41], v[208:209]
    v_mov_b64 v[42:43], v[208:209]
    v_mov_b64 v[44:45], v[208:209]
    v_mov_b64 v[46:47], v[208:209]
    s_mov_b64 exec, 0x000f000f
    v_mov_b32 v216, v48
    v_mov_b32 v217, v48
    v_mov_b32 v218, v48
    v_mov_b32 v219, v48
    s_mov_b64 exec, -1
    s_mov_b32 s60, 2
    s_waitcnt lgkmcnt(0)
    s_branch L_q_go
L_q_cs2:
    s_mov_b32 s60, 0
    s_cmp_eq_u32 s36, 0
    v_cvt_pk_bf16_f32 v48, v192, v193
    v_min_u32 v48, -2, v48
    s_cbranch_scc1 L_sg_64
    buffer_store_dword v48, v26, s[20:23], s35 offen
L_se_65:
    v_xor_b32 v26, 256, v26
L_poll_66:
    buffer_load_dword v56, v26, s[20:23], s35 offen sc1
    s_sub_u32 s37, s37, 1
    s_cmp_lt_i32 s37, 0
    s_cbranch_scc1 L_pdone_67
    s_sleep 2
    s_waitcnt vmcnt(0)
    v_cmp_eq_u32 vcc, -1, v56
    s_cbranch_vccnz L_poll_66
L_pdone_67:
    v_lshlrev_b32 v48, 16, v56
    v_and_b32 v49, 0xffff0000, v56
    v_add_f32 v48, v48, v192
    v_add_f32 v49, v49, v193
    v_cvt_pk_bf16_f32 v48, v48, v48
    v_cvt_pk_bf16_f32 v49, v49, v49
    v_mov_b32 v100, v48
    v_mov_b32 v148, v49
    v_mov_b32 v101, v48
    v_mov_b32 v149, v49
    v_mov_b32 v102, v48
    v_mov_b32 v150, v49
    v_mov_b32 v103, v48
    v_mov_b32 v151, v49
    v_mov_b32 v104, v48
    v_mov_b32 v152, v49
    v_mov_b32 v105, v48
    v_mov_b32 v153, v49
    v_mov_b32 v106, v48
    v_mov_b32 v154, v49
    v_mov_b32 v107, v48
    v_mov_b32 v155, v49
    s_cmp_eq_u32 s3, 0
    s_cbranch_scc0 L_w_next
    s_cmp_eq_u32 s101, 0
    s_cbranch_scc1 L_rg2
    s_branch L_fl
L_q_swap:
    s_lshl1_add_u32 s96, s34, s101
    s_cmp_eq_u32 s96, 2
    s_cbranch_scc0 L_skip_68
    s_lshl2_add_u32 s96, s32, s3
    s_mul_i32 s96, s96, 147456
    s_lshl_b32 s97, s100, 7
    s_add_u32 s96, s96, s97
    s_add_u32 s96, s96, 101376
    v_min_u32 v56, 39, v1
    v_mul_u32_u24 v56, 1152, v56
    buffer_load_dword v244, v56, s[4:7], s96 offen
    s_nop 0
L_skip_68:
    v_mov_b64 v[180:181], v[184:185]
    v_mov_b64 v[182:183], v[186:187]
    v_swap_b32 v64, v112
    v_swap_b32 v65, v113
    v_swap_b32 v66, v114
    v_swap_b32 v67, v115
    v_swap_b32 v68, v116
    v_swap_b32 v69, v117
    v_swap_b32 v70, v118
    v_swap_b32 v71, v119
    v_swap_b32 v72, v120
    v_swap_b32 v73, v121
    v_swap_b32 v74, v122
    v_swap_b32 v75, v123
    v_swap_b32 v76, v124
    v_swap_b32 v77, v125
    v_swap_b32 v78, v126
    v_swap_b32 v79, v127
    v_swap_b32 v80, v128
    v_swap_b32 v81, v129
    v_swap_b32 v82, v130
    v_swap_b32 v83, v131
    v_swap_b32 v84, v132
    v_swap_b32 v85, v133
    v_swap_b32 v86, v134
    v_swap_b32 v87, v135
    v_swap_b32 v88, v136
    v_swap_b32 v89, v137
    v_swap_b32 v90, v138
    v_swap_b32 v91, v139
    v_swap_b32 v92, v140
    v_swap_b32 v93, v141
    v_swap_b32 v94, v142
    v_swap_b32 v95, v143
    v_swap_b32 v96, v144
    v_swap_b32 v97, v145
    v_swap_b32 v98, v146
    v_swap_b32 v99, v147
    v_swap_b32 v100, v148
    v_swap_b32 v101, v149
    v_swap_b32 v102, v150
    v_swap_b32 v103, v151
    v_swap_b32 v104, v152
    v_swap_b32 v105, v153
    v_swap_b32 v106, v154
    v_swap_b32 v107, v155
    s_and_b32 s96, s34, 1
    s_cmp_eq_u32 s96, s101
    s_cbranch_scc0 L_q_idle
    s_cmp_eq_u32 s3, 0
    s_cbranch_scc1 L_rg
    s_barrier
    s_cmp_eq_u32 s3, 1
    s_cbranch_scc0 L_skip_69
    s_cmp_eq_u32 s36, 0
    s_mov_b64 exec, 1
    s_cbranch_scc1 L_sg_70
    buffer_store_dword v12, v12, s[20:23], s35 offen
L_se_71:
    s_mov_b64 exec, -1
L_skip_69:
    s_branch L_w_next
L_q_idle:
    s_cmp_eq_u32 s3, 0
    s_cbranch_scc1 L_fl
    s_branch L_w_next
L_q_cs:
    s_cmp_eq_u32 s60, 0
    s_nop 1
    v_permlane16_swap_b32 v48, v52
    v_add_f32 v48, v48, v52
    v_add_f32 v50, v160, v161
    v_add_f32 v50, v50, v48
    s_cbranch_scc1 L_q_far
    v_mov_b32 v193, v192
    v_mul_f32 v192, 0xbae38e39, v50
    v_cvt_pk_bf16_f32 v50, v192, v192
    s_nop 1
    v_mov_b32 v100, v50
    v_mov_b32 v101, v50
    v_mov_b32 v102, v50
    v_mov_b32 v103, v50
    v_mov_b32 v104, v50
    v_mov_b32 v105, v50
    v_mov_b32 v106, v50
    v_mov_b32 v107, v50
    s_cmp_eq_u32 s60, 1
    s_cbranch_scc1 L_q_cs1
    s_branch L_q_cs2
L_w_next:
    s_cmp_eq_u32 s34, 3
    s_cbranch_scc1 L_w_end
    s_add_u32 s34, s34, 1
    s_add_u32 s35, s35, 16384
    s_mov_b32 s55, s35
    v_mov_b64 v[160:161], 0
    v_mov_b64 v[162:163], 0
    v_mov_b64 v[164:165], 0
    v_mov_b64 v[166:167], 0
    v_mov_b64 v[168:169], 0
    v_mov_b64 v[170:171], 0
    v_mov_b64 v[172:173], 0
    v_mov_b64 v[174:175], 0
    v_mov_b64 v[176:177], 0
    v_mov_b64 v[178:179], 0
    s_branch L_bx
L_w_end:
L_end:
    s_endpgm
L_k_fix:
    s_sub_u32 s37, s37, 1
    s_cmp_lt_i32 s37, 0
    s_cbranch_scc1 L_k_out
    v_cmp_u_f32 vcc, v50, v51
    s_cbranch_vccnz L_k_again
    s_waitcnt vmcnt(0)
    v_pk_add_f32 v[196:197], v[192:193], v[194:195]
    buffer_load_dwordx4 v[192:195], v17, s[20:23], s35 offen sc1
    v_pk_mul_f32 v[196:197], v[196:197], s[40:41]
    v_fma_f32 v196, -v196, v196, v197
    v_add_f32 v196, |v196|, s42
    v_rsq_f32 v196, v196
    s_nop 1
    v_readfirstlane_b32 s17, v196
    s_nop 1
    s_cmp_eq_u32 s34, 0
    s_branch L_k_ok
L_k_out:
    s_cmp_eq_u32 s34, 0
    s_branch L_k_on
L_sg_11:
    v_mul_f32 v207, v59, v58
    buffer_store_dwordx2 v[206:207], v20, s[20:23], s35 offen sc1
    s_branch L_se_12
L_sg_23:
    v_mov_b32 v56, 132608
    ds_read_b32 v57, v56
    s_waitcnt lgkmcnt(0)
    v_readfirstlane_b32 s36, v57
    s_nop 3
    s_cmp_eq_u32 s36, 0
    s_cbranch_scc0 L_sf_25
    s_nop 0
    v_permlane32_swap_b32 v48, v50
    v_add_f32 v48, v48, v50
    v_cvt_pk_bf16_f32 v48, v48, v48
    buffer_store_short v48, v17, s[20:23], s35 offen sc1
    s_branch L_se_24
L_st1:
    s_waitcnt lgkmcnt(0)
    v_dot2c_f32_bf16 v50, 0x3f803f80, v208
    v_dot2c_f32_bf16 v50, 0x3f803f80, v209
    v_dot2c_f32_bf16 v50, 0x3f803f80, v210
    v_dot2c_f32_bf16 v50, 0x3f803f80, v211
    v_dot2c_f32_bf16 v50, 0x3f803f80, v212
    s_branch L_st2
L_sg_47:
    s_nop 0
    v_permlane16_swap_b32 v50, v52
    v_add_f32 v50, v50, v52
    buffer_store_dword v50, v13, s[20:23], s35 offen sc1
    s_branch L_se_48
L_rt_51:
    s_sub_u32 s37, s37, 1
    s_cmp_lt_i32 s37, 0
    s_cbranch_scc1 L_rc_52
    s_nop 15
    s_branch L_o_again
L_sg_62:
    buffer_store_dword v12, v12, s[20:23], s35 offen sc1
    s_branch L_se_63
L_sg_64:
    buffer_store_dword v48, v26, s[20:23], s35 offen sc1
    s_branch L_se_65
L_sg_70:
    buffer_store_dword v12, v12, s[20:23], s35 offen sc1
    s_branch L_se_71
L_q_far:
    v_cvt_pk_bf16_f32 v50, v50, v50
    buffer_store_short v50, v29, s[20:23], s55 offen sc1
    s_branch L_q_st
L_text_end:
.section .rodata,"a"
.p2align 6
.amdhsa_kernel interleave_layers__sliding_block_cached__sliding_block_cached__decode_kernel
  .amdhsa_next_free_vgpr 256
  .amdhsa_next_free_sgpr 102
  .amdhsa_accum_offset 256
  .amdhsa_group_segment_fixed_size 0
  .amdhsa_kernarg_size 104
  .amdhsa_user_sgpr_count 2
  .amdhsa_user_sgpr_kernarg_segment_ptr 1
  .amdhsa_system_sgpr_workgroup_id_x 1
.end_amdhsa_kernel
```
